```python
import torch

def _softmax(x, axis=-1):
    return torch.softmax(x, dim=axis)
def _gelu(x):
    return torch.nn.functional.gelu(x, approximate="tanh")
def _silu(x):
    return torch.nn.functional.silu(x)
def _sigmoid(x):
    return torch.sigmoid(x)
def _layernorm(x, axis=-1, eps=1e-5):
    m = x.mean(dim=axis, keepdim=True)
    v = x.var(dim=axis, keepdim=True, unbiased=False)
    return (x - m) / torch.sqrt(v + eps)
def _scatter_add(tgt, idx, src, axis=0):
    return tgt.clone().index_add_(axis, idx, src)
def _segment_sum(src, seg, n):
    out = torch.zeros((n,) + src.shape[1:], dtype=src.dtype)
    return out.index_add_(0, seg, src)
def _pad(x, pw):
    flat = tuple(v for pair in reversed(pw) for v in pair)
    return torch.nn.functional.pad(x, flat)

kernel_name = 'recurrent_scan__sliding_block__glu_gated_bilinear__prompt'

def setup_inputs():

    _w = (lambda a: (lambda t: t.to(torch.bfloat16) if t.is_floating_point() else t)(torch.as_tensor(a)))
    def _A_setup():
        B, S, D = 1, 2048, 448
        return {
            "x": _w((lambda *s: torch.randn(*s, dtype=torch.bfloat16) * 0.05)(B, S, D)),
            "wqkv": _w((lambda *s: torch.randn(*s, dtype=torch.bfloat16) * 0.2)(D, 3 * D)),
            "wo": _w((lambda *s: torch.randn(*s, dtype=torch.bfloat16) * 0.2)(D, D)),
        }
    _A_in = _A_setup()

    def _B_setup():
        B, S, D, F = 1, 2048, 448, 1792
        return {
            "x": _w((lambda *s: torch.randn(*s, dtype=torch.bfloat16) * 0.05)(B, S, D)),
            "w_gate": _w((lambda *s: torch.randn(*s, dtype=torch.bfloat16) * 0.1)(D, F) * (D ** -0.5)),
            "w_up": _w((lambda *s: torch.randn(*s, dtype=torch.bfloat16) * 0.1)(D, F) * (D ** -0.5)),
            "w_down": _w((lambda *s: torch.randn(*s, dtype=torch.bfloat16) * 0.1)(F, D) * (F ** -0.5)),
        }
    _B_in = _B_setup()

    return {
        "A_x": _A_in["x"],
        "A_wqkv": _A_in["wqkv"],
        "A_wo": _A_in["wo"],
        "B_x": _B_in["x"],
        "B_w_gate": _B_in["w_gate"],
        "B_w_up": _B_in["w_up"],
        "B_w_down": _B_in["w_down"],
    }

def reference(A_x, A_wqkv, A_wo, B_x, B_w_gate, B_w_up, B_w_down):
    def _A_ref(x, wqkv, wo):
        B, S, D = x.shape
        H = 16; Dh = D // H; W = 256
        qkv = (lambda x, *d: x.permute(*d))((x @ wqkv).reshape(B, S, 3, H, Dh), 2, 0, 3, 1, 4)
        q, k, v = qkv[0], qkv[1], qkv[2]
        scores = torch.einsum("bhqd,bhkd->bhqk", q, k) * (Dh ** -0.5)
        idx = torch.arange(S)
        mask = (idx[:, None] - idx[None, :] >= 0) & (idx[:, None] - idx[None, :] < W)
        scores = torch.where(mask[None, None], scores, -1e9)
        p = _softmax(scores, axis=-1)
        o = torch.einsum("bhqk,bhkd->bhqd", p, v)
        return (lambda x, *d: x.permute(*d))(o, 0, 2, 1, 3).reshape(B, S, D) @ wo

    def _B_ref(x, w_gate, w_up, w_down):
        g = torch.einsum("bsd,df->bsf", x, w_gate)
        u = torch.einsum("bsd,df->bsf", x, w_up)
        h = g * u
        return torch.einsum("bsf,fd->bsd", h, w_down)

    x = A_x
    xn = _layernorm(x, axis=-1)
    s = _A_ref(xn, A_wqkv, A_wo)
    g = _silu(_B_ref(xn, B_w_gate, B_w_up, B_w_down))
    return x + s * g
```

```asm
; @launch kernel=recurrent_scan__sliding_block__glu_gated_bilinear__prompt_kernel grid=(256,1,1) block=(512,1,1) lds=163840
.amdgcn_target "amdgcn-amd-amdhsa--gfx950"
.text
.globl recurrent_scan__sliding_block__glu_gated_bilinear__prompt_kernel
.p2align 8
.type recurrent_scan__sliding_block__glu_gated_bilinear__prompt_kernel,@function
recurrent_scan__sliding_block__glu_gated_bilinear__prompt_kernel:
    s_cmp_ge_u32 s2, 256
    s_cbranch_scc1 K1_END
    s_load_dwordx2 s[16:17], s[0:1], 0
    s_load_dwordx2 s[8:9], s[0:1], 8
    s_load_dwordx4 s[12:15], s[0:1], 32
    s_load_dwordx2 s[10:11], s[0:1], 72
    s_load_dwordx2 s[94:95], s[0:1], 48
    s_load_dwordx2 s[96:97], s[0:1], 16
    s_mov_b32 s93, 401408
    v_and_b32 v1, 63, v0
    v_lshrrev_b32 v238, 6, v0
    v_lshlrev_b32 v2, 4, v1
    v_readfirstlane_b32 s3, v238
    s_and_b32 s54, s2, 7
    s_lshr_b32 s55, s2, 3
    s_and_b32 s35, s54, 1
    s_lshl_b32 s35, s35, 3
    s_and_b32 s56, s55, 7
    s_add_u32 s35, s35, s56
    s_lshr_b32 s36, s54, 1
    s_lshl_b32 s36, s36, 2
    s_lshr_b32 s56, s55, 3
    s_add_u32 s36, s36, s56
    s_mul_i32 s37, s36, 5
    s_and_b32 s33, s3, 3
    s_lshr_b32 s34, s3, 2
    s_and_b32 s39, s3, 1
    s_lshr_b32 s32, s3, 1
    s_and_b32 s86, s36, 3
    s_lshl_b32 s86, s86, 1
    s_add_u32 s86, s86, s3
    s_and_b32 s86, s86, 7
    s_lshl_b32 s38, s35, 2
    s_add_u32 s38, s38, s33
    s_mov_b32 s40, 0
    s_mov_b32 s41, -1
    v_bfe_u32 v238, v1, 2, 2
    v_and_b32 v239, 3, v1
    v_bfe_u32 v240, v1, 4, 1
    v_lshrrev_b32 v241, 5, v1
    v_lshl_add_u32 v242, v240, 2, v239
    v_and_b32 v243, 1, v242
    v_lshlrev_b32 v243, 2, v243
    v_lshrrev_b32 v244, 1, v242
    v_or_b32 v243, v243, v244
    v_min_u32 v243, 6, v243
    s_mul_i32 s54, s34, 56
    v_lshlrev_b32 v243, 3, v243
    v_add_u32 v243, s54, v243
    v_lshrrev_b32 v244, 4, v243
    v_bfe_u32 v245, v238, 1, 1
    v_lshlrev_b32 v245, 2, v245
    v_xor_b32 v244, v244, v245
    v_and_b32 v243, 15, v243
    v_lshl_add_u32 v243, v244, 4, v243
    v_lshl_add_u32 v245, v241, 3, v238
    v_lshl_add_u32 v246, v245, 7, v243
    s_lshl_b32 s54, s34, 1
    v_and_b32 v243, 1, v239
    v_add_u32 v243, s54, v243
    v_lshlrev_b32 v244, 1, v240
    v_xor_b32 v243, v243, v244
    v_lshlrev_b32 v243, 4, v243
    v_lshrrev_b32 v244, 1, v239
    v_lshl_add_u32 v243, v244, 3, v243
    v_lshl_add_u32 v243, v245, 6, v243
    v_lshl_add_u32 v247, v240, 10, v243
    v_lshrrev_b32 v243, 3, v1
    v_and_b32 v244, 7, v1
    v_bfe_u32 v245, v1, 4, 1
    v_lshlrev_b32 v245, 2, v245
    v_xor_b32 v244, v244, v245
    v_lshlrev_b32 v244, 4, v244
    s_movk_i32 s54, 2688
    v_mad_u32_u24 v248, v243, s54, v244
    v_lshrrev_b32 v243, 2, v1
    v_lshlrev_b32 v244, 4, v239
    s_movk_i32 s54, 3584
    v_mad_u32_u24 v249, v243, s54, v244
    s_lshl_b32 s54, s39, 5
    v_xor_b32 v249, s54, v249
    v_lshrrev_b32 v243, 2, v1
    s_movk_i32 s54, 896
    v_lshlrev_b32 v244, 4, v239
    v_mad_u32_u24 v20, v243, s54, v244
    s_and_b32 s55, s86, 1
    s_lshl_b32 s55, s55, 4
    v_add_u32 v243, s55, v243
    s_movk_i32 s54, 464
    v_mad_u32_u24 v21, v243, s54, v244
    s_lshr_b32 s55, s86, 1
    s_lshl_b32 s55, s55, 15
    s_add_u32 s55, s55, 16384
    v_add_u32 v21, s55, v21
    v_and_b32 v243, 31, v1
    v_lshlrev_b32 v244, 4, v241
    v_mad_u32_u24 v22, v243, s54, v244
    s_lshl_b32 s55, s33, 15
    s_add_u32 s55, s55, 16384
    v_add_u32 v22, s55, v22
    s_lshl_b32 s58, s3, 10
    s_waitcnt lgkmcnt(0)
    s_mov_b32 s4, s16
    s_mov_b32 s5, s17
    s_mov_b32 s6, 1835008
    s_mov_b32 s7, 0x00020000
    s_mov_b32 s20, s10
    s_mov_b32 s21, s11
    s_mov_b32 s22, 268435456
    s_mov_b32 s23, 0x00020000
    s_cmp_lg_u32 s2, 0
    s_cbranch_scc1 K1_NOZ
    s_cmp_lg_u32 s3, 0
    s_cbranch_scc1 K1_NOZ
    v_lshlrev_b32 v243, 7, v1
    v_mov_b32 v244, 0
    s_mov_b32 s54, 0xF00000
    buffer_store_dword v244, v243, s[20:23], s54 offen sc0 sc1
    s_mov_b32 s54, 0xF02000
    buffer_store_dword v244, v243, s[20:23], s54 offen sc0 sc1
    s_load_dwordx2 s[88:89], s[0:1], 64
    s_waitcnt vmcnt(0) lgkmcnt(0)
    s_mov_b32 s90, 256
    s_mov_b32 s91, 0x00020000
    v_mov_b32 v243, 0
    v_mov_b32 v244, 1
    s_mov_b64 exec, 1
    buffer_store_dword v244, v243, s[88:91], 0 offen sc0 sc1
    s_mov_b64 exec, -1
K1_NOZ:
    s_lshl_b32 s54, s86, 4
    s_lshl_b32 s55, s35, 7
    s_add_u32 s55, s55, s54
    s_mul_i32 s55, s55, 896
    buffer_load_dwordx4 v[116:119], v20, s[4:7], s55 offen offset:0
    buffer_load_dwordx4 v[120:123], v20, s[4:7], s55 offen offset:64
    buffer_load_dwordx4 v[124:127], v20, s[4:7], s55 offen offset:128
    buffer_load_dwordx4 v[128:131], v20, s[4:7], s55 offen offset:192
    buffer_load_dwordx4 v[132:135], v20, s[4:7], s55 offen offset:256
    buffer_load_dwordx4 v[136:139], v20, s[4:7], s55 offen offset:320
    buffer_load_dwordx4 v[140:143], v20, s[4:7], s55 offen offset:384
    buffer_load_dwordx4 v[144:147], v20, s[4:7], s55 offen offset:448
    buffer_load_dwordx4 v[148:151], v20, s[4:7], s55 offen offset:512
    buffer_load_dwordx4 v[152:155], v20, s[4:7], s55 offen offset:576
    buffer_load_dwordx4 v[156:159], v20, s[4:7], s55 offen offset:640
    buffer_load_dwordx4 v[160:163], v20, s[4:7], s55 offen offset:704
    buffer_load_dwordx4 v[164:167], v20, s[4:7], s55 offen offset:768
    buffer_load_dwordx4 v[168:171], v20, s[4:7], s55 offen offset:832
    s_cmp_eq_u32 s39, 1
    s_cselect_b64 s[18:19], s[14:15], s[12:13]
    s_mul_i32 s56, s32, 57344
    s_mul_i32 s57, s32, 43008
    s_mul_i32 s54, s39, 21504
    s_add_u32 s57, s57, s54
    s_mov_b32 s30, 1204224
    s_mov_b32 s31, 172032
    s_mov_b32 s29, 512
    s_add_u32 s54, s37, 0
    s_lshl_b32 s55, s54, 6
    s_add_u32 s55, s55, s56
    s_sub_u32 s59, s54, 56
    s_mul_i32 s59, s59, 112
    s_add_u32 s59, s59, s57
    s_cmp_lt_u32 s54, 56
    s_cselect_b64 s[60:61], s[18:19], s[8:9]
    s_cselect_b32 s62, 1605632, s30
    s_mov_b32 s63, 0x00020000
    s_cselect_b32 s44, s55, s59
    s_cselect_b32 s49, 229376, s31
    s_cselect_b64 s[42:43], -1, 0
    v_cndmask_b32 v3, v248, v249, s[42:43]
    v_cndmask_b32 v8, v246, v247, s[42:43]
    s_cselect_b32 s55, 256, s29
    v_add_u32 v8, 0, v8
    v_add_u32 v9, s55, v8
    s_add_u32 s54, s37, 1
    s_lshl_b32 s55, s54, 6
    s_add_u32 s55, s55, s56
    s_sub_u32 s59, s54, 56
    s_mul_i32 s59, s59, 112
    s_add_u32 s59, s59, s57
    s_cmp_lt_u32 s54, 56
    s_cselect_b64 s[64:65], s[18:19], s[8:9]
    s_cselect_b32 s66, 1605632, s30
    s_mov_b32 s67, 0x00020000
    s_cselect_b32 s45, s55, s59
    s_cselect_b32 s50, 229376, s31
    s_cselect_b64 s[42:43], -1, 0
    v_cndmask_b32 v4, v248, v249, s[42:43]
    v_cndmask_b32 v10, v246, v247, s[42:43]
    s_cselect_b32 s55, 256, s29
    v_add_u32 v10, 32768, v10
    v_add_u32 v11, s55, v10
    s_add_u32 s54, s37, 2
    s_lshl_b32 s55, s54, 6
    s_add_u32 s55, s55, s56
    s_sub_u32 s59, s54, 56
    s_mul_i32 s59, s59, 112
    s_add_u32 s59, s59, s57
    s_cmp_lt_u32 s54, 56
    s_cselect_b64 s[68:69], s[18:19], s[8:9]
    s_cselect_b32 s70, 1605632, s30
    s_mov_b32 s71, 0x00020000
    s_cselect_b32 s46, s55, s59
    s_cselect_b32 s51, 229376, s31
    s_cselect_b64 s[42:43], -1, 0
    v_cndmask_b32 v5, v248, v249, s[42:43]
    v_cndmask_b32 v12, v246, v247, s[42:43]
    s_cselect_b32 s55, 256, s29
    v_add_u32 v12, 65536, v12
    v_add_u32 v13, s55, v12
    s_add_u32 s54, s37, 3
    s_lshl_b32 s55, s54, 6
    s_add_u32 s55, s55, s56
    s_sub_u32 s59, s54, 56
    s_mul_i32 s59, s59, 112
    s_add_u32 s59, s59, s57
    s_cmp_lt_u32 s54, 56
    s_cselect_b64 s[72:73], s[18:19], s[8:9]
    s_cselect_b32 s74, 1605632, s30
    s_mov_b32 s75, 0x00020000
    s_cselect_b32 s47, s55, s59
    s_cselect_b32 s52, 229376, s31
    s_cselect_b64 s[42:43], -1, 0
    v_cndmask_b32 v6, v248, v249, s[42:43]
    v_cndmask_b32 v14, v246, v247, s[42:43]
    s_cselect_b32 s55, 256, s29
    v_add_u32 v14, 98304, v14
    v_add_u32 v15, s55, v14
    s_add_u32 s54, s37, 4
    s_lshl_b32 s55, s54, 6
    s_add_u32 s55, s55, s56
    s_sub_u32 s59, s54, 56
    s_mul_i32 s59, s59, 112
    s_add_u32 s59, s59, s57
    s_cmp_lt_u32 s54, 56
    s_cselect_b64 s[76:77], s[18:19], s[8:9]
    s_cselect_b32 s78, 1605632, s30
    s_mov_b32 s79, 0x00020000
    s_cselect_b32 s48, s55, s59
    s_cselect_b32 s53, 229376, s31
    s_cselect_b64 s[42:43], -1, 0
    v_cndmask_b32 v7, v248, v249, s[42:43]
    v_cndmask_b32 v16, v246, v247, s[42:43]
    s_cselect_b32 s55, 256, s29
    v_add_u32 v16, 131072, v16
    v_add_u32 v17, s55, v16
    s_lshr_b32 s92, s2, 3
    s_lshl_b32 s92, s92, 3
    s_add_u32 s92, s92, s3
    s_cmp_lt_u32 s92, 196
    s_cselect_b64 s[88:89], s[94:95], s[96:97]
    s_cselect_b32 s90, 1605632, s93
    s_mov_b32 s91, 0x00020000
    s_cselect_b32 s93, 0, 196
    s_sub_u32 s92, s92, s93
    s_lshl_b32 s92, s92, 13
    s_barrier
    s_add_u32 m0, s58, 0
    s_nop 0
    buffer_load_dwordx4 v3, s[60:63], s44 offen lds
    s_add_u32 s44, s44, s49
    s_add_u32 m0, s58, 32768
    s_nop 0
    buffer_load_dwordx4 v4, s[64:67], s45 offen lds
    s_add_u32 s45, s45, s50
    s_add_u32 m0, s58, 65536
    s_nop 0
    buffer_load_dwordx4 v5, s[68:71], s46 offen lds
    s_add_u32 s46, s46, s51
    s_add_u32 m0, s58, 98304
    s_nop 0
    buffer_load_dwordx4 v6, s[72:75], s47 offen lds
    s_add_u32 s47, s47, s52
    s_add_u32 m0, s58, 131072
    s_nop 0
    buffer_load_dwordx4 v7, s[76:79], s48 offen lds
    s_add_u32 s48, s48, s53
    s_add_u32 m0, s58, 8192
    s_nop 0
    buffer_load_dwordx4 v3, s[60:63], s44 offen lds
    s_add_u32 s44, s44, s49
    s_add_u32 m0, s58, 40960
    s_nop 0
    buffer_load_dwordx4 v4, s[64:67], s45 offen lds
    s_add_u32 s45, s45, s50
    s_add_u32 m0, s58, 73728
    s_nop 0
    buffer_load_dwordx4 v5, s[68:71], s46 offen lds
    s_add_u32 s46, s46, s51
    s_add_u32 m0, s58, 106496
    s_nop 0
    buffer_load_dwordx4 v6, s[72:75], s47 offen lds
    s_add_u32 s47, s47, s52
    s_add_u32 m0, s58, 139264
    s_nop 0
    buffer_load_dwordx4 v7, s[76:79], s48 offen lds
    s_add_u32 s48, s48, s53
    s_waitcnt vmcnt(23)
    v_mov_b32 v238, 0
    v_mov_b32 v239, 0
    v_mov_b32 v240, 0
    v_mov_b32 v241, 0
    s_mov_b32 s54, 0x3f803f80
    v_dot2_f32_bf16 v238, v116, s54, v238
    v_dot2_f32_bf16 v240, v116, v116, v240
    v_dot2_f32_bf16 v239, v117, s54, v239
    v_dot2_f32_bf16 v241, v117, v117, v241
    v_dot2_f32_bf16 v238, v118, s54, v238
    v_dot2_f32_bf16 v240, v118, v118, v240
    v_dot2_f32_bf16 v239, v119, s54, v239
    v_dot2_f32_bf16 v241, v119, v119, v241
    s_waitcnt vmcnt(22)
    v_dot2_f32_bf16 v238, v120, s54, v238
    v_dot2_f32_bf16 v240, v120, v120, v240
    v_dot2_f32_bf16 v239, v121, s54, v239
    v_dot2_f32_bf16 v241, v121, v121, v241
    v_dot2_f32_bf16 v238, v122, s54, v238
    v_dot2_f32_bf16 v240, v122, v122, v240
    v_dot2_f32_bf16 v239, v123, s54, v239
    v_dot2_f32_bf16 v241, v123, v123, v241
    s_waitcnt vmcnt(21)
    v_dot2_f32_bf16 v238, v124, s54, v238
    v_dot2_f32_bf16 v240, v124, v124, v240
    v_dot2_f32_bf16 v239, v125, s54, v239
    v_dot2_f32_bf16 v241, v125, v125, v241
    v_dot2_f32_bf16 v238, v126, s54, v238
    v_dot2_f32_bf16 v240, v126, v126, v240
    v_dot2_f32_bf16 v239, v127, s54, v239
    v_dot2_f32_bf16 v241, v127, v127, v241
    s_waitcnt vmcnt(20)
    v_dot2_f32_bf16 v238, v128, s54, v238
    v_dot2_f32_bf16 v240, v128, v128, v240
    v_dot2_f32_bf16 v239, v129, s54, v239
    v_dot2_f32_bf16 v241, v129, v129, v241
    v_dot2_f32_bf16 v238, v130, s54, v238
    v_dot2_f32_bf16 v240, v130, v130, v240
    v_dot2_f32_bf16 v239, v131, s54, v239
    v_dot2_f32_bf16 v241, v131, v131, v241
    s_waitcnt vmcnt(19)
    v_dot2_f32_bf16 v238, v132, s54, v238
    v_dot2_f32_bf16 v240, v132, v132, v240
    v_dot2_f32_bf16 v239, v133, s54, v239
    v_dot2_f32_bf16 v241, v133, v133, v241
    v_dot2_f32_bf16 v238, v134, s54, v238
    v_dot2_f32_bf16 v240, v134, v134, v240
    v_dot2_f32_bf16 v239, v135, s54, v239
    v_dot2_f32_bf16 v241, v135, v135, v241
    s_waitcnt vmcnt(18)
    v_dot2_f32_bf16 v238, v136, s54, v238
    v_dot2_f32_bf16 v240, v136, v136, v240
    v_dot2_f32_bf16 v239, v137, s54, v239
    v_dot2_f32_bf16 v241, v137, v137, v241
    v_dot2_f32_bf16 v238, v138, s54, v238
    v_dot2_f32_bf16 v240, v138, v138, v240
    v_dot2_f32_bf16 v239, v139, s54, v239
    v_dot2_f32_bf16 v241, v139, v139, v241
    s_waitcnt vmcnt(17)
    v_dot2_f32_bf16 v238, v140, s54, v238
    v_dot2_f32_bf16 v240, v140, v140, v240
    v_dot2_f32_bf16 v239, v141, s54, v239
    v_dot2_f32_bf16 v241, v141, v141, v241
    v_dot2_f32_bf16 v238, v142, s54, v238
    v_dot2_f32_bf16 v240, v142, v142, v240
    v_dot2_f32_bf16 v239, v143, s54, v239
    v_dot2_f32_bf16 v241, v143, v143, v241
    s_waitcnt vmcnt(16)
    v_dot2_f32_bf16 v238, v144, s54, v238
    v_dot2_f32_bf16 v240, v144, v144, v240
    v_dot2_f32_bf16 v239, v145, s54, v239
    v_dot2_f32_bf16 v241, v145, v145, v241
    v_dot2_f32_bf16 v238, v146, s54, v238
    v_dot2_f32_bf16 v240, v146, v146, v240
    v_dot2_f32_bf16 v239, v147, s54, v239
    v_dot2_f32_bf16 v241, v147, v147, v241
    s_waitcnt vmcnt(15)
    v_dot2_f32_bf16 v238, v148, s54, v238
    v_dot2_f32_bf16 v240, v148, v148, v240
    v_dot2_f32_bf16 v239, v149, s54, v239
    v_dot2_f32_bf16 v241, v149, v149, v241
    v_dot2_f32_bf16 v238, v150, s54, v238
    v_dot2_f32_bf16 v240, v150, v150, v240
    v_dot2_f32_bf16 v239, v151, s54, v239
    v_dot2_f32_bf16 v241, v151, v151, v241
    s_waitcnt vmcnt(14)
    v_dot2_f32_bf16 v238, v152, s54, v238
    v_dot2_f32_bf16 v240, v152, v152, v240
    v_dot2_f32_bf16 v239, v153, s54, v239
    v_dot2_f32_bf16 v241, v153, v153, v241
    v_dot2_f32_bf16 v238, v154, s54, v238
    v_dot2_f32_bf16 v240, v154, v154, v240
    v_dot2_f32_bf16 v239, v155, s54, v239
    v_dot2_f32_bf16 v241, v155, v155, v241
    s_waitcnt vmcnt(13)
    v_dot2_f32_bf16 v238, v156, s54, v238
    v_dot2_f32_bf16 v240, v156, v156, v240
    v_dot2_f32_bf16 v239, v157, s54, v239
    v_dot2_f32_bf16 v241, v157, v157, v241
    v_dot2_f32_bf16 v238, v158, s54, v238
    v_dot2_f32_bf16 v240, v158, v158, v240
    v_dot2_f32_bf16 v239, v159, s54, v239
    v_dot2_f32_bf16 v241, v159, v159, v241
    s_waitcnt vmcnt(12)
    v_dot2_f32_bf16 v238, v160, s54, v238
    v_dot2_f32_bf16 v240, v160, v160, v240
    v_dot2_f32_bf16 v239, v161, s54, v239
    v_dot2_f32_bf16 v241, v161, v161, v241
    v_dot2_f32_bf16 v238, v162, s54, v238
    v_dot2_f32_bf16 v240, v162, v162, v240
    v_dot2_f32_bf16 v239, v163, s54, v239
    v_dot2_f32_bf16 v241, v163, v163, v241
    s_waitcnt vmcnt(11)
    v_dot2_f32_bf16 v238, v164, s54, v238
    v_dot2_f32_bf16 v240, v164, v164, v240
    v_dot2_f32_bf16 v239, v165, s54, v239
    v_dot2_f32_bf16 v241, v165, v165, v241
    v_dot2_f32_bf16 v238, v166, s54, v238
    v_dot2_f32_bf16 v240, v166, v166, v240
    v_dot2_f32_bf16 v239, v167, s54, v239
    v_dot2_f32_bf16 v241, v167, v167, v241
    s_waitcnt vmcnt(10)
    v_dot2_f32_bf16 v238, v168, s54, v238
    v_dot2_f32_bf16 v240, v168, v168, v240
    v_dot2_f32_bf16 v239, v169, s54, v239
    v_dot2_f32_bf16 v241, v169, v169, v241
    v_dot2_f32_bf16 v238, v170, s54, v238
    v_dot2_f32_bf16 v240, v170, v170, v240
    v_dot2_f32_bf16 v239, v171, s54, v239
    v_dot2_f32_bf16 v241, v171, v171, v241
    s_nop 1
    v_add_f32 v238, v238, v239
    v_add_f32 v240, v240, v241
    s_nop 0
    v_add_f32_dpp v238, v238, v238 quad_perm:[1,0,3,2] row_mask:0xf bank_mask:0xf
    v_add_f32_dpp v240, v240, v240 quad_perm:[1,0,3,2] row_mask:0xf bank_mask:0xf
    s_nop 0
    v_add_f32_dpp v238, v238, v238 quad_perm:[2,3,0,1] row_mask:0xf bank_mask:0xf
    v_add_f32_dpp v240, v240, v240 quad_perm:[2,3,0,1] row_mask:0xf bank_mask:0xf
    v_mul_f32 v242, 0x3b124925, v238
    v_mul_f32 v243, 0x3b124925, v240
    v_fma_f32 v243, -v242, v242, v243
    v_max_f32 v243, 0, v243
    v_cvt_pk_bf16_f32 v242, v242, v242
    v_lshlrev_b32 v242, 16, v242
    v_cvt_pk_bf16_f32 v243, v243, v243
    v_lshlrev_b32 v243, 16, v243
    v_add_f32 v243, 0x3727c5ac, v243
    v_cvt_pk_bf16_f32 v243, v243, v243
    v_lshlrev_b32 v243, 16, v243
    v_sqrt_f32 v243, v243
    s_nop 0
    v_cvt_pk_bf16_f32 v243, v243, v243
    v_lshlrev_b32 v243, 16, v243
    v_rcp_f32 v244, v243
    s_nop 0
    v_mul_f32 v245, v242, v244
    v_sub_f32 v245, 0, v245
    v_lshlrev_b32 v36, 16, v116
    v_lshlrev_b32 v38, 16, v117
    v_lshlrev_b32 v40, 16, v118
    v_lshlrev_b32 v42, 16, v119
    v_lshlrev_b32 v44, 16, v120
    v_lshlrev_b32 v46, 16, v121
    v_lshlrev_b32 v48, 16, v122
    v_lshlrev_b32 v50, 16, v123
    v_and_b32 v37, 0xffff0000, v116
    v_and_b32 v39, 0xffff0000, v117
    v_and_b32 v41, 0xffff0000, v118
    v_and_b32 v43, 0xffff0000, v119
    v_and_b32 v45, 0xffff0000, v120
    v_and_b32 v47, 0xffff0000, v121
    v_and_b32 v49, 0xffff0000, v122
    v_and_b32 v51, 0xffff0000, v123
    v_fma_f32 v36, v36, v244, v245
    v_fma_f32 v37, v37, v244, v245
    v_fma_f32 v38, v38, v244, v245
    v_fma_f32 v39, v39, v244, v245
    v_fma_f32 v40, v40, v244, v245
    v_fma_f32 v41, v41, v244, v245
    v_fma_f32 v42, v42, v244, v245
    v_fma_f32 v43, v43, v244, v245
    v_fma_f32 v44, v44, v244, v245
    v_fma_f32 v45, v45, v244, v245
    v_fma_f32 v46, v46, v244, v245
    v_fma_f32 v47, v47, v244, v245
    v_fma_f32 v48, v48, v244, v245
    v_fma_f32 v49, v49, v244, v245
    v_fma_f32 v50, v50, v244, v245
    v_fma_f32 v51, v51, v244, v245
    v_cvt_pk_bf16_f32 v172, v36, v37
    v_cvt_pk_bf16_f32 v173, v38, v39
    v_cvt_pk_bf16_f32 v174, v40, v41
    v_cvt_pk_bf16_f32 v175, v42, v43
    v_cvt_pk_bf16_f32 v176, v44, v45
    v_cvt_pk_bf16_f32 v177, v46, v47
    v_cvt_pk_bf16_f32 v178, v48, v49
    v_cvt_pk_bf16_f32 v179, v50, v51
    v_lshlrev_b32 v36, 16, v124
    v_lshlrev_b32 v38, 16, v125
    v_lshlrev_b32 v40, 16, v126
    v_lshlrev_b32 v42, 16, v127
    v_lshlrev_b32 v44, 16, v128
    v_lshlrev_b32 v46, 16, v129
    v_lshlrev_b32 v48, 16, v130
    v_lshlrev_b32 v50, 16, v131
    v_and_b32 v37, 0xffff0000, v124
    v_and_b32 v39, 0xffff0000, v125
    v_and_b32 v41, 0xffff0000, v126
    v_and_b32 v43, 0xffff0000, v127
    v_and_b32 v45, 0xffff0000, v128
    v_and_b32 v47, 0xffff0000, v129
    v_and_b32 v49, 0xffff0000, v130
    v_and_b32 v51, 0xffff0000, v131
    v_fma_f32 v36, v36, v244, v245
    v_fma_f32 v37, v37, v244, v245
    v_fma_f32 v38, v38, v244, v245
    v_fma_f32 v39, v39, v244, v245
    v_fma_f32 v40, v40, v244, v245
    v_fma_f32 v41, v41, v244, v245
    v_fma_f32 v42, v42, v244, v245
    v_fma_f32 v43, v43, v244, v245
    v_fma_f32 v44, v44, v244, v245
    v_fma_f32 v45, v45, v244, v245
    v_fma_f32 v46, v46, v244, v245
    v_fma_f32 v47, v47, v244, v245
    v_fma_f32 v48, v48, v244, v245
    v_fma_f32 v49, v49, v244, v245
    v_fma_f32 v50, v50, v244, v245
    v_fma_f32 v51, v51, v244, v245
    v_cvt_pk_bf16_f32 v180, v36, v37
    v_cvt_pk_bf16_f32 v181, v38, v39
    v_cvt_pk_bf16_f32 v182, v40, v41
    v_cvt_pk_bf16_f32 v183, v42, v43
    v_cvt_pk_bf16_f32 v184, v44, v45
    v_cvt_pk_bf16_f32 v185, v46, v47
    v_cvt_pk_bf16_f32 v186, v48, v49
    v_cvt_pk_bf16_f32 v187, v50, v51
    v_lshlrev_b32 v36, 16, v132
    v_lshlrev_b32 v38, 16, v133
    v_lshlrev_b32 v40, 16, v134
    v_lshlrev_b32 v42, 16, v135
    v_lshlrev_b32 v44, 16, v136
    v_lshlrev_b32 v46, 16, v137
    v_lshlrev_b32 v48, 16, v138
    v_lshlrev_b32 v50, 16, v139
    v_and_b32 v37, 0xffff0000, v132
    v_and_b32 v39, 0xffff0000, v133
    v_and_b32 v41, 0xffff0000, v134
    v_and_b32 v43, 0xffff0000, v135
    v_and_b32 v45, 0xffff0000, v136
    v_and_b32 v47, 0xffff0000, v137
    v_and_b32 v49, 0xffff0000, v138
    v_and_b32 v51, 0xffff0000, v139
    v_fma_f32 v36, v36, v244, v245
    v_fma_f32 v37, v37, v244, v245
    v_fma_f32 v38, v38, v244, v245
    v_fma_f32 v39, v39, v244, v245
    v_fma_f32 v40, v40, v244, v245
    v_fma_f32 v41, v41, v244, v245
    v_fma_f32 v42, v42, v244, v245
    v_fma_f32 v43, v43, v244, v245
    v_fma_f32 v44, v44, v244, v245
    v_fma_f32 v45, v45, v244, v245
    v_fma_f32 v46, v46, v244, v245
    v_fma_f32 v47, v47, v244, v245
    v_fma_f32 v48, v48, v244, v245
    v_fma_f32 v49, v49, v244, v245
    v_fma_f32 v50, v50, v244, v245
    v_fma_f32 v51, v51, v244, v245
    v_cvt_pk_bf16_f32 v188, v36, v37
    v_cvt_pk_bf16_f32 v189, v38, v39
    v_cvt_pk_bf16_f32 v190, v40, v41
    v_cvt_pk_bf16_f32 v191, v42, v43
    v_cvt_pk_bf16_f32 v192, v44, v45
    v_cvt_pk_bf16_f32 v193, v46, v47
    v_cvt_pk_bf16_f32 v194, v48, v49
    v_cvt_pk_bf16_f32 v195, v50, v51
    v_lshlrev_b32 v36, 16, v140
    v_lshlrev_b32 v38, 16, v141
    v_lshlrev_b32 v40, 16, v142
    v_lshlrev_b32 v42, 16, v143
    v_lshlrev_b32 v44, 16, v144
    v_lshlrev_b32 v46, 16, v145
    v_lshlrev_b32 v48, 16, v146
    v_lshlrev_b32 v50, 16, v147
    v_and_b32 v37, 0xffff0000, v140
    v_and_b32 v39, 0xffff0000, v141
    v_and_b32 v41, 0xffff0000, v142
    v_and_b32 v43, 0xffff0000, v143
    v_and_b32 v45, 0xffff0000, v144
    v_and_b32 v47, 0xffff0000, v145
    v_and_b32 v49, 0xffff0000, v146
    v_and_b32 v51, 0xffff0000, v147
    v_fma_f32 v36, v36, v244, v245
    v_fma_f32 v37, v37, v244, v245
    v_fma_f32 v38, v38, v244, v245
    v_fma_f32 v39, v39, v244, v245
    v_fma_f32 v40, v40, v244, v245
    v_fma_f32 v41, v41, v244, v245
    v_fma_f32 v42, v42, v244, v245
    v_fma_f32 v43, v43, v244, v245
    v_fma_f32 v44, v44, v244, v245
    v_fma_f32 v45, v45, v244, v245
    v_fma_f32 v46, v46, v244, v245
    v_fma_f32 v47, v47, v244, v245
    v_fma_f32 v48, v48, v244, v245
    v_fma_f32 v49, v49, v244, v245
    v_fma_f32 v50, v50, v244, v245
    v_fma_f32 v51, v51, v244, v245
    v_cvt_pk_bf16_f32 v196, v36, v37
    v_cvt_pk_bf16_f32 v197, v38, v39
    v_cvt_pk_bf16_f32 v198, v40, v41
    v_cvt_pk_bf16_f32 v199, v42, v43
    v_cvt_pk_bf16_f32 v200, v44, v45
    v_cvt_pk_bf16_f32 v201, v46, v47
    v_cvt_pk_bf16_f32 v202, v48, v49
    v_cvt_pk_bf16_f32 v203, v50, v51
    ds_write_b128 v21, v[172:175] offset:0
    ds_write_b128 v21, v[176:179] offset:64
    ds_write_b128 v21, v[180:183] offset:128
    ds_write_b128 v21, v[184:187] offset:192
    ds_write_b128 v21, v[188:191] offset:256
    ds_write_b128 v21, v[192:195] offset:320
    ds_write_b128 v21, v[196:199] offset:384
    v_lshlrev_b32 v36, 16, v148
    v_lshlrev_b32 v38, 16, v149
    v_lshlrev_b32 v40, 16, v150
    v_lshlrev_b32 v42, 16, v151
    v_lshlrev_b32 v44, 16, v152
    v_lshlrev_b32 v46, 16, v153
    v_lshlrev_b32 v48, 16, v154
    v_lshlrev_b32 v50, 16, v155
    v_and_b32 v37, 0xffff0000, v148
    v_and_b32 v39, 0xffff0000, v149
    v_and_b32 v41, 0xffff0000, v150
    v_and_b32 v43, 0xffff0000, v151
    v_and_b32 v45, 0xffff0000, v152
    v_and_b32 v47, 0xffff0000, v153
    v_and_b32 v49, 0xffff0000, v154
    v_and_b32 v51, 0xffff0000, v155
    v_fma_f32 v36, v36, v244, v245
    v_fma_f32 v37, v37, v244, v245
    v_fma_f32 v38, v38, v244, v245
    v_fma_f32 v39, v39, v244, v245
    v_fma_f32 v40, v40, v244, v245
    v_fma_f32 v41, v41, v244, v245
    v_fma_f32 v42, v42, v244, v245
    v_fma_f32 v43, v43, v244, v245
    v_fma_f32 v44, v44, v244, v245
    v_fma_f32 v45, v45, v244, v245
    v_fma_f32 v46, v46, v244, v245
    v_fma_f32 v47, v47, v244, v245
    v_fma_f32 v48, v48, v244, v245
    v_fma_f32 v49, v49, v244, v245
    v_fma_f32 v50, v50, v244, v245
    v_fma_f32 v51, v51, v244, v245
    v_cvt_pk_bf16_f32 v204, v36, v37
    v_cvt_pk_bf16_f32 v205, v38, v39
    v_cvt_pk_bf16_f32 v206, v40, v41
    v_cvt_pk_bf16_f32 v207, v42, v43
    v_cvt_pk_bf16_f32 v208, v44, v45
    v_cvt_pk_bf16_f32 v209, v46, v47
    v_cvt_pk_bf16_f32 v210, v48, v49
    v_cvt_pk_bf16_f32 v211, v50, v51
    v_lshlrev_b32 v36, 16, v156
    v_lshlrev_b32 v38, 16, v157
    v_lshlrev_b32 v40, 16, v158
    v_lshlrev_b32 v42, 16, v159
    v_lshlrev_b32 v44, 16, v160
    v_lshlrev_b32 v46, 16, v161
    v_lshlrev_b32 v48, 16, v162
    v_lshlrev_b32 v50, 16, v163
    v_and_b32 v37, 0xffff0000, v156
    v_and_b32 v39, 0xffff0000, v157
    v_and_b32 v41, 0xffff0000, v158
    v_and_b32 v43, 0xffff0000, v159
    v_and_b32 v45, 0xffff0000, v160
    v_and_b32 v47, 0xffff0000, v161
    v_and_b32 v49, 0xffff0000, v162
    v_and_b32 v51, 0xffff0000, v163
    v_fma_f32 v36, v36, v244, v245
    v_fma_f32 v37, v37, v244, v245
    v_fma_f32 v38, v38, v244, v245
    v_fma_f32 v39, v39, v244, v245
    v_fma_f32 v40, v40, v244, v245
    v_fma_f32 v41, v41, v244, v245
    v_fma_f32 v42, v42, v244, v245
    v_fma_f32 v43, v43, v244, v245
    v_fma_f32 v44, v44, v244, v245
    v_fma_f32 v45, v45, v244, v245
    v_fma_f32 v46, v46, v244, v245
    v_fma_f32 v47, v47, v244, v245
    v_fma_f32 v48, v48, v244, v245
    v_fma_f32 v49, v49, v244, v245
    v_fma_f32 v50, v50, v244, v245
    v_fma_f32 v51, v51, v244, v245
    v_cvt_pk_bf16_f32 v212, v36, v37
    v_cvt_pk_bf16_f32 v213, v38, v39
    v_cvt_pk_bf16_f32 v214, v40, v41
    v_cvt_pk_bf16_f32 v215, v42, v43
    v_cvt_pk_bf16_f32 v216, v44, v45
    v_cvt_pk_bf16_f32 v217, v46, v47
    v_cvt_pk_bf16_f32 v218, v48, v49
    v_cvt_pk_bf16_f32 v219, v50, v51
    v_lshlrev_b32 v36, 16, v164
    v_lshlrev_b32 v38, 16, v165
    v_lshlrev_b32 v40, 16, v166
    v_lshlrev_b32 v42, 16, v167
    v_lshlrev_b32 v44, 16, v168
    v_lshlrev_b32 v46, 16, v169
    v_lshlrev_b32 v48, 16, v170
    v_lshlrev_b32 v50, 16, v171
    v_and_b32 v37, 0xffff0000, v164
    v_and_b32 v39, 0xffff0000, v165
    v_and_b32 v41, 0xffff0000, v166
    v_and_b32 v43, 0xffff0000, v167
    v_and_b32 v45, 0xffff0000, v168
    v_and_b32 v47, 0xffff0000, v169
    v_and_b32 v49, 0xffff0000, v170
    v_and_b32 v51, 0xffff0000, v171
    v_fma_f32 v36, v36, v244, v245
    v_fma_f32 v37, v37, v244, v245
    v_fma_f32 v38, v38, v244, v245
    v_fma_f32 v39, v39, v244, v245
    v_fma_f32 v40, v40, v244, v245
    v_fma_f32 v41, v41, v244, v245
    v_fma_f32 v42, v42, v244, v245
    v_fma_f32 v43, v43, v244, v245
    v_fma_f32 v44, v44, v244, v245
    v_fma_f32 v45, v45, v244, v245
    v_fma_f32 v46, v46, v244, v245
    v_fma_f32 v47, v47, v244, v245
    v_fma_f32 v48, v48, v244, v245
    v_fma_f32 v49, v49, v244, v245
    v_fma_f32 v50, v50, v244, v245
    v_fma_f32 v51, v51, v244, v245
    v_cvt_pk_bf16_f32 v220, v36, v37
    v_cvt_pk_bf16_f32 v221, v38, v39
    v_cvt_pk_bf16_f32 v222, v40, v41
    v_cvt_pk_bf16_f32 v223, v42, v43
    v_cvt_pk_bf16_f32 v224, v44, v45
    v_cvt_pk_bf16_f32 v225, v46, v47
    v_cvt_pk_bf16_f32 v226, v48, v49
    v_cvt_pk_bf16_f32 v227, v50, v51
    s_waitcnt lgkmcnt(0)
    s_barrier
    ds_read_b128 v[116:119], v22 offset:0
    ds_read_b128 v[120:123], v22 offset:32
    ds_read_b128 v[124:127], v22 offset:64
    ds_read_b128 v[128:131], v22 offset:96
    ds_read_b128 v[132:135], v22 offset:128
    ds_read_b128 v[136:139], v22 offset:160
    ds_read_b128 v[140:143], v22 offset:192
    ds_read_b128 v[144:147], v22 offset:224
    ds_read_b128 v[148:151], v22 offset:256
    ds_read_b128 v[152:155], v22 offset:288
    ds_read_b128 v[156:159], v22 offset:320
    ds_read_b128 v[160:163], v22 offset:352
    ds_read_b128 v[164:167], v22 offset:384
    ds_read_b128 v[168:171], v22 offset:416
    s_waitcnt lgkmcnt(0)
    s_barrier
    ds_write_b128 v21, v[200:203] offset:0
    ds_write_b128 v21, v[204:207] offset:64
    ds_write_b128 v21, v[208:211] offset:128
    ds_write_b128 v21, v[212:215] offset:192
    ds_write_b128 v21, v[216:219] offset:256
    ds_write_b128 v21, v[220:223] offset:320
    ds_write_b128 v21, v[224:227] offset:384
    s_waitcnt lgkmcnt(0)
    s_barrier
    ds_read_b128 v[172:175], v22 offset:0
    ds_read_b128 v[176:179], v22 offset:32
    ds_read_b128 v[180:183], v22 offset:64
    ds_read_b128 v[184:187], v22 offset:96
    ds_read_b128 v[188:191], v22 offset:128
    ds_read_b128 v[192:195], v22 offset:160
    ds_read_b128 v[196:199], v22 offset:192
    ds_read_b128 v[200:203], v22 offset:224
    ds_read_b128 v[204:207], v22 offset:256
    ds_read_b128 v[208:211], v22 offset:288
    ds_read_b128 v[212:215], v22 offset:320
    ds_read_b128 v[216:219], v22 offset:352
    ds_read_b128 v[220:223], v22 offset:384
    ds_read_b128 v[224:227], v22 offset:416
    s_waitcnt lgkmcnt(0) vmcnt(0)
    s_barrier
    s_add_u32 m0, s58, 16384
    s_nop 0
    buffer_load_dwordx4 v3, s[60:63], s44 offen lds
    s_add_u32 s44, s44, s49
    s_add_u32 m0, s58, 49152
    s_nop 0
    buffer_load_dwordx4 v4, s[64:67], s45 offen lds
    s_add_u32 s45, s45, s50
    s_add_u32 m0, s58, 81920
    s_nop 0
    buffer_load_dwordx4 v5, s[68:71], s46 offen lds
    s_add_u32 s46, s46, s51
    s_add_u32 m0, s58, 114688
    s_nop 0
    buffer_load_dwordx4 v6, s[72:75], s47 offen lds
    s_add_u32 s47, s47, s52
    s_add_u32 m0, s58, 147456
    s_nop 0
    buffer_load_dwordx4 v7, s[76:79], s48 offen lds
    s_add_u32 s48, s48, s53
    s_add_u32 m0, s58, 24576
    s_nop 0
    buffer_load_dwordx4 v3, s[60:63], s44 offen lds
    s_add_u32 s44, s44, s49
    s_add_u32 m0, s58, 57344
    s_nop 0
    buffer_load_dwordx4 v4, s[64:67], s45 offen lds
    s_add_u32 s45, s45, s50
    s_add_u32 m0, s58, 90112
    s_nop 0
    buffer_load_dwordx4 v5, s[68:71], s46 offen lds
    s_add_u32 s46, s46, s51
    s_add_u32 m0, s58, 122880
    s_nop 0
    buffer_load_dwordx4 v6, s[72:75], s47 offen lds
    s_add_u32 s47, s47, s52
    s_add_u32 m0, s58, 155648
    s_nop 0
    buffer_load_dwordx4 v7, s[76:79], s48 offen lds
    s_add_u32 s48, s48, s53
    ds_read_b64_tr_b16 v[20:21], v8 offset:0
    ds_read_b64_tr_b16 v[22:23], v9 offset:0
    ds_read_b64_tr_b16 v[24:25], v10 offset:0
    ds_read_b64_tr_b16 v[26:27], v11 offset:0
    ds_read_b64_tr_b16 v[28:29], v12 offset:0
    ds_read_b64_tr_b16 v[30:31], v13 offset:0
    ds_read_b64_tr_b16 v[32:33], v14 offset:0
    ds_read_b64_tr_b16 v[34:35], v15 offset:0
    s_waitcnt lgkmcnt(6)
    v_mfma_f32_32x32x16_bf16 v[36:51], v[20:23], v[116:119], 0
    ds_read_b64_tr_b16 v[20:21], v16 offset:0
    ds_read_b64_tr_b16 v[22:23], v17 offset:0
    s_waitcnt lgkmcnt(6)
    v_mfma_f32_32x32x16_bf16 v[52:67], v[24:27], v[116:119], 0
    ds_read_b64_tr_b16 v[24:25], v8 offset:2048
    ds_read_b64_tr_b16 v[26:27], v9 offset:2048
    s_waitcnt lgkmcnt(6)
    v_mfma_f32_32x32x16_bf16 v[68:83], v[28:31], v[116:119], 0
    ds_read_b64_tr_b16 v[28:29], v10 offset:2048
    ds_read_b64_tr_b16 v[30:31], v11 offset:2048
    s_waitcnt lgkmcnt(6)
    v_mfma_f32_32x32x16_bf16 v[84:99], v[32:35], v[116:119], 0
    ds_read_b64_tr_b16 v[32:33], v12 offset:2048
    ds_read_b64_tr_b16 v[34:35], v13 offset:2048
    s_waitcnt lgkmcnt(6)
    v_mfma_f32_32x32x16_bf16 v[100:115], v[20:23], v[116:119], 0
    ds_read_b64_tr_b16 v[20:21], v14 offset:2048
    ds_read_b64_tr_b16 v[22:23], v15 offset:2048
    s_waitcnt lgkmcnt(6)
    v_mfma_f32_32x32x16_bf16 v[36:51], v[24:27], v[120:123], v[36:51]
    ds_read_b64_tr_b16 v[24:25], v16 offset:2048
    ds_read_b64_tr_b16 v[26:27], v17 offset:2048
    s_waitcnt lgkmcnt(6)
    v_mfma_f32_32x32x16_bf16 v[52:67], v[28:31], v[120:123], v[52:67]
    ds_read_b64_tr_b16 v[28:29], v8 offset:4096
    ds_read_b64_tr_b16 v[30:31], v9 offset:4096
    s_waitcnt lgkmcnt(6)
    v_mfma_f32_32x32x16_bf16 v[68:83], v[32:35], v[120:123], v[68:83]
    ds_read_b64_tr_b16 v[32:33], v10 offset:4096
    ds_read_b64_tr_b16 v[34:35], v11 offset:4096
    s_waitcnt lgkmcnt(6)
    v_mfma_f32_32x32x16_bf16 v[84:99], v[20:23], v[120:123], v[84:99]
    ds_read_b64_tr_b16 v[20:21], v12 offset:4096
    ds_read_b64_tr_b16 v[22:23], v13 offset:4096
    s_waitcnt lgkmcnt(6)
    v_mfma_f32_32x32x16_bf16 v[100:115], v[24:27], v[120:123], v[100:115]
    ds_read_b64_tr_b16 v[24:25], v14 offset:4096
    ds_read_b64_tr_b16 v[26:27], v15 offset:4096
    s_waitcnt lgkmcnt(6)
    v_mfma_f32_32x32x16_bf16 v[36:51], v[28:31], v[124:127], v[36:51]
    ds_read_b64_tr_b16 v[28:29], v16 offset:4096
    ds_read_b64_tr_b16 v[30:31], v17 offset:4096
    s_waitcnt lgkmcnt(6)
    v_mfma_f32_32x32x16_bf16 v[52:67], v[32:35], v[124:127], v[52:67]
    ds_read_b64_tr_b16 v[32:33], v8 offset:6144
    ds_read_b64_tr_b16 v[34:35], v9 offset:6144
    s_waitcnt lgkmcnt(6)
    v_mfma_f32_32x32x16_bf16 v[68:83], v[20:23], v[124:127], v[68:83]
    ds_read_b64_tr_b16 v[20:21], v10 offset:6144
    ds_read_b64_tr_b16 v[22:23], v11 offset:6144
    s_waitcnt lgkmcnt(6)
    v_mfma_f32_32x32x16_bf16 v[84:99], v[24:27], v[124:127], v[84:99]
    ds_read_b64_tr_b16 v[24:25], v12 offset:6144
    ds_read_b64_tr_b16 v[26:27], v13 offset:6144
    s_waitcnt lgkmcnt(6)
    v_mfma_f32_32x32x16_bf16 v[100:115], v[28:31], v[124:127], v[100:115]
    ds_read_b64_tr_b16 v[28:29], v14 offset:6144
    ds_read_b64_tr_b16 v[30:31], v15 offset:6144
    s_waitcnt lgkmcnt(6)
    v_mfma_f32_32x32x16_bf16 v[36:51], v[32:35], v[128:131], v[36:51]
    ds_read_b64_tr_b16 v[32:33], v16 offset:6144
    ds_read_b64_tr_b16 v[34:35], v17 offset:6144
    s_waitcnt lgkmcnt(6)
    v_mfma_f32_32x32x16_bf16 v[52:67], v[20:23], v[128:131], v[52:67]
    ds_read_b64_tr_b16 v[20:21], v8 offset:8192
    ds_read_b64_tr_b16 v[22:23], v9 offset:8192
    s_waitcnt lgkmcnt(6)
    v_mfma_f32_32x32x16_bf16 v[68:83], v[24:27], v[128:131], v[68:83]
    ds_read_b64_tr_b16 v[24:25], v10 offset:8192
    ds_read_b64_tr_b16 v[26:27], v11 offset:8192
    s_waitcnt lgkmcnt(6)
    v_mfma_f32_32x32x16_bf16 v[84:99], v[28:31], v[128:131], v[84:99]
    ds_read_b64_tr_b16 v[28:29], v12 offset:8192
    ds_read_b64_tr_b16 v[30:31], v13 offset:8192
    s_waitcnt lgkmcnt(6)
    v_mfma_f32_32x32x16_bf16 v[100:115], v[32:35], v[128:131], v[100:115]
    s_barrier
    s_add_u32 m0, s58, 0
    s_nop 0
    buffer_load_dwordx4 v3, s[60:63], s44 offen lds
    s_add_u32 s44, s44, s49
    s_add_u32 m0, s58, 32768
    s_nop 0
    buffer_load_dwordx4 v4, s[64:67], s45 offen lds
    s_add_u32 s45, s45, s50
    s_add_u32 m0, s58, 65536
    s_nop 0
    buffer_load_dwordx4 v5, s[68:71], s46 offen lds
    s_add_u32 s46, s46, s51
    s_add_u32 m0, s58, 98304
    s_nop 0
    buffer_load_dwordx4 v6, s[72:75], s47 offen lds
    s_add_u32 s47, s47, s52
    s_add_u32 m0, s58, 131072
    s_nop 0
    buffer_load_dwordx4 v7, s[76:79], s48 offen lds
    s_add_u32 s48, s48, s53
    s_add_u32 s54, s92, 0
    buffer_load_dwordx4 v[228:231], v2, s[88:91], s54 offen
    s_add_u32 s54, s92, 1024
    buffer_load_dwordx4 v[232:235], v2, s[88:91], s54 offen
    ds_read_b64_tr_b16 v[32:33], v14 offset:8192
    ds_read_b64_tr_b16 v[34:35], v15 offset:8192
    s_waitcnt lgkmcnt(6)
    v_mfma_f32_32x32x16_bf16 v[36:51], v[20:23], v[132:135], v[36:51]
    ds_read_b64_tr_b16 v[20:21], v16 offset:8192
    ds_read_b64_tr_b16 v[22:23], v17 offset:8192
    s_waitcnt lgkmcnt(6)
    v_mfma_f32_32x32x16_bf16 v[52:67], v[24:27], v[132:135], v[52:67]
    ds_read_b64_tr_b16 v[24:25], v8 offset:10240
    ds_read_b64_tr_b16 v[26:27], v9 offset:10240
    s_waitcnt lgkmcnt(6)
    v_mfma_f32_32x32x16_bf16 v[68:83], v[28:31], v[132:135], v[68:83]
    ds_read_b64_tr_b16 v[28:29], v10 offset:10240
    ds_read_b64_tr_b16 v[30:31], v11 offset:10240
    s_waitcnt lgkmcnt(6)
    v_mfma_f32_32x32x16_bf16 v[84:99], v[32:35], v[132:135], v[84:99]
    ds_read_b64_tr_b16 v[32:33], v12 offset:10240
    ds_read_b64_tr_b16 v[34:35], v13 offset:10240
    s_waitcnt lgkmcnt(6)
    v_mfma_f32_32x32x16_bf16 v[100:115], v[20:23], v[132:135], v[100:115]
    ds_read_b64_tr_b16 v[20:21], v14 offset:10240
    ds_read_b64_tr_b16 v[22:23], v15 offset:10240
    s_waitcnt lgkmcnt(6)
    v_mfma_f32_32x32x16_bf16 v[36:51], v[24:27], v[136:139], v[36:51]
    ds_read_b64_tr_b16 v[24:25], v16 offset:10240
    ds_read_b64_tr_b16 v[26:27], v17 offset:10240
    s_waitcnt lgkmcnt(6)
    v_mfma_f32_32x32x16_bf16 v[52:67], v[28:31], v[136:139], v[52:67]
    ds_read_b64_tr_b16 v[28:29], v8 offset:12288
    ds_read_b64_tr_b16 v[30:31], v9 offset:12288
    s_waitcnt lgkmcnt(6)
    v_mfma_f32_32x32x16_bf16 v[68:83], v[32:35], v[136:139], v[68:83]
    ds_read_b64_tr_b16 v[32:33], v10 offset:12288
    ds_read_b64_tr_b16 v[34:35], v11 offset:12288
    s_waitcnt lgkmcnt(6)
    v_mfma_f32_32x32x16_bf16 v[84:99], v[20:23], v[136:139], v[84:99]
    ds_read_b64_tr_b16 v[20:21], v12 offset:12288
    ds_read_b64_tr_b16 v[22:23], v13 offset:12288
    s_waitcnt lgkmcnt(6)
    v_mfma_f32_32x32x16_bf16 v[100:115], v[24:27], v[136:139], v[100:115]
    ds_read_b64_tr_b16 v[24:25], v14 offset:12288
    ds_read_b64_tr_b16 v[26:27], v15 offset:12288
    s_waitcnt lgkmcnt(6)
    v_mfma_f32_32x32x16_bf16 v[36:51], v[28:31], v[140:143], v[36:51]
    ds_read_b64_tr_b16 v[28:29], v16 offset:12288
    ds_read_b64_tr_b16 v[30:31], v17 offset:12288
    s_waitcnt lgkmcnt(6)
    v_mfma_f32_32x32x16_bf16 v[52:67], v[32:35], v[140:143], v[52:67]
    ds_read_b64_tr_b16 v[32:33], v8 offset:14336
    ds_read_b64_tr_b16 v[34:35], v9 offset:14336
    s_waitcnt lgkmcnt(6)
    v_mfma_f32_32x32x16_bf16 v[68:83], v[20:23], v[140:143], v[68:83]
    ds_read_b64_tr_b16 v[20:21], v10 offset:14336
    ds_read_b64_tr_b16 v[22:23], v11 offset:14336
    s_waitcnt lgkmcnt(6)
    v_mfma_f32_32x32x16_bf16 v[84:99], v[24:27], v[140:143], v[84:99]
    ds_read_b64_tr_b16 v[24:25], v12 offset:14336
    ds_read_b64_tr_b16 v[26:27], v13 offset:14336
    s_waitcnt lgkmcnt(6)
    v_mfma_f32_32x32x16_bf16 v[100:115], v[28:31], v[140:143], v[100:115]
    ds_read_b64_tr_b16 v[28:29], v14 offset:14336
    ds_read_b64_tr_b16 v[30:31], v15 offset:14336
    s_waitcnt lgkmcnt(6)
    v_mfma_f32_32x32x16_bf16 v[36:51], v[32:35], v[144:147], v[36:51]
    ds_read_b64_tr_b16 v[32:33], v16 offset:14336
    ds_read_b64_tr_b16 v[34:35], v17 offset:14336
    s_waitcnt lgkmcnt(6)
    v_mfma_f32_32x32x16_bf16 v[52:67], v[20:23], v[144:147], v[52:67]
    s_waitcnt lgkmcnt(4)
    v_mfma_f32_32x32x16_bf16 v[68:83], v[24:27], v[144:147], v[68:83]
    s_waitcnt lgkmcnt(2)
    v_mfma_f32_32x32x16_bf16 v[84:99], v[28:31], v[144:147], v[84:99]
    s_waitcnt lgkmcnt(0)
    v_mfma_f32_32x32x16_bf16 v[100:115], v[32:35], v[144:147], v[100:115]
    s_waitcnt vmcnt(7)
    s_barrier
    s_add_u32 m0, s58, 8192
    s_nop 0
    buffer_load_dwordx4 v3, s[60:63], s44 offen lds
    s_add_u32 s44, s44, s49
    s_add_u32 m0, s58, 40960
    s_nop 0
    buffer_load_dwordx4 v4, s[64:67], s45 offen lds
    s_add_u32 s45, s45, s50
    s_add_u32 m0, s58, 73728
    s_nop 0
    buffer_load_dwordx4 v5, s[68:71], s46 offen lds
    s_add_u32 s46, s46, s51
    s_add_u32 m0, s58, 106496
    s_nop 0
    buffer_load_dwordx4 v6, s[72:75], s47 offen lds
    s_add_u32 s47, s47, s52
    s_add_u32 m0, s58, 139264
    s_nop 0
    buffer_load_dwordx4 v7, s[76:79], s48 offen lds
    s_add_u32 s48, s48, s53
    s_add_u32 s54, s92, 2048
    buffer_load_dwordx4 v[228:231], v2, s[88:91], s54 offen
    s_add_u32 s54, s92, 3072
    buffer_load_dwordx4 v[232:235], v2, s[88:91], s54 offen
    ds_read_b64_tr_b16 v[20:21], v8 offset:16384
    ds_read_b64_tr_b16 v[22:23], v9 offset:16384
    ds_read_b64_tr_b16 v[24:25], v10 offset:16384
    ds_read_b64_tr_b16 v[26:27], v11 offset:16384
    ds_read_b64_tr_b16 v[28:29], v12 offset:16384
    ds_read_b64_tr_b16 v[30:31], v13 offset:16384
    ds_read_b64_tr_b16 v[32:33], v14 offset:16384
    ds_read_b64_tr_b16 v[34:35], v15 offset:16384
    s_waitcnt lgkmcnt(6)
    v_mfma_f32_32x32x16_bf16 v[36:51], v[20:23], v[148:151], v[36:51]
    ds_read_b64_tr_b16 v[20:21], v16 offset:16384
    ds_read_b64_tr_b16 v[22:23], v17 offset:16384
    s_waitcnt lgkmcnt(6)
    v_mfma_f32_32x32x16_bf16 v[52:67], v[24:27], v[148:151], v[52:67]
    ds_read_b64_tr_b16 v[24:25], v8 offset:18432
    ds_read_b64_tr_b16 v[26:27], v9 offset:18432
    s_waitcnt lgkmcnt(6)
    v_mfma_f32_32x32x16_bf16 v[68:83], v[28:31], v[148:151], v[68:83]
    ds_read_b64_tr_b16 v[28:29], v10 offset:18432
    ds_read_b64_tr_b16 v[30:31], v11 offset:18432
    s_waitcnt lgkmcnt(6)
    v_mfma_f32_32x32x16_bf16 v[84:99], v[32:35], v[148:151], v[84:99]
    ds_read_b64_tr_b16 v[32:33], v12 offset:18432
    ds_read_b64_tr_b16 v[34:35], v13 offset:18432
    s_waitcnt lgkmcnt(6)
    v_mfma_f32_32x32x16_bf16 v[100:115], v[20:23], v[148:151], v[100:115]
    ds_read_b64_tr_b16 v[20:21], v14 offset:18432
    ds_read_b64_tr_b16 v[22:23], v15 offset:18432
    s_waitcnt lgkmcnt(6)
    v_mfma_f32_32x32x16_bf16 v[36:51], v[24:27], v[152:155], v[36:51]
    ds_read_b64_tr_b16 v[24:25], v16 offset:18432
    ds_read_b64_tr_b16 v[26:27], v17 offset:18432
    s_waitcnt lgkmcnt(6)
    v_mfma_f32_32x32x16_bf16 v[52:67], v[28:31], v[152:155], v[52:67]
    ds_read_b64_tr_b16 v[28:29], v8 offset:20480
    ds_read_b64_tr_b16 v[30:31], v9 offset:20480
    s_waitcnt lgkmcnt(6)
    v_mfma_f32_32x32x16_bf16 v[68:83], v[32:35], v[152:155], v[68:83]
    ds_read_b64_tr_b16 v[32:33], v10 offset:20480
    ds_read_b64_tr_b16 v[34:35], v11 offset:20480
    s_waitcnt lgkmcnt(6)
    v_mfma_f32_32x32x16_bf16 v[84:99], v[20:23], v[152:155], v[84:99]
    ds_read_b64_tr_b16 v[20:21], v12 offset:20480
    ds_read_b64_tr_b16 v[22:23], v13 offset:20480
    s_waitcnt lgkmcnt(6)
    v_mfma_f32_32x32x16_bf16 v[100:115], v[24:27], v[152:155], v[100:115]
    ds_read_b64_tr_b16 v[24:25], v14 offset:20480
    ds_read_b64_tr_b16 v[26:27], v15 offset:20480
    s_waitcnt lgkmcnt(6)
    v_mfma_f32_32x32x16_bf16 v[36:51], v[28:31], v[156:159], v[36:51]
    ds_read_b64_tr_b16 v[28:29], v16 offset:20480
    ds_read_b64_tr_b16 v[30:31], v17 offset:20480
    s_waitcnt lgkmcnt(6)
    v_mfma_f32_32x32x16_bf16 v[52:67], v[32:35], v[156:159], v[52:67]
    ds_read_b64_tr_b16 v[32:33], v8 offset:22528
    ds_read_b64_tr_b16 v[34:35], v9 offset:22528
    s_waitcnt lgkmcnt(6)
    v_mfma_f32_32x32x16_bf16 v[68:83], v[20:23], v[156:159], v[68:83]
    ds_read_b64_tr_b16 v[20:21], v10 offset:22528
    ds_read_b64_tr_b16 v[22:23], v11 offset:22528
    s_waitcnt lgkmcnt(6)
    v_mfma_f32_32x32x16_bf16 v[84:99], v[24:27], v[156:159], v[84:99]
    ds_read_b64_tr_b16 v[24:25], v12 offset:22528
    ds_read_b64_tr_b16 v[26:27], v13 offset:22528
    s_waitcnt lgkmcnt(6)
    v_mfma_f32_32x32x16_bf16 v[100:115], v[28:31], v[156:159], v[100:115]
    ds_read_b64_tr_b16 v[28:29], v14 offset:22528
    ds_read_b64_tr_b16 v[30:31], v15 offset:22528
    s_waitcnt lgkmcnt(6)
    v_mfma_f32_32x32x16_bf16 v[36:51], v[32:35], v[160:163], v[36:51]
    ds_read_b64_tr_b16 v[32:33], v16 offset:22528
    ds_read_b64_tr_b16 v[34:35], v17 offset:22528
    s_waitcnt lgkmcnt(6)
    v_mfma_f32_32x32x16_bf16 v[52:67], v[20:23], v[160:163], v[52:67]
    ds_read_b64_tr_b16 v[20:21], v8 offset:24576
    ds_read_b64_tr_b16 v[22:23], v9 offset:24576
    s_waitcnt lgkmcnt(6)
    v_mfma_f32_32x32x16_bf16 v[68:83], v[24:27], v[160:163], v[68:83]
    ds_read_b64_tr_b16 v[24:25], v10 offset:24576
    ds_read_b64_tr_b16 v[26:27], v11 offset:24576
    s_waitcnt lgkmcnt(6)
    v_mfma_f32_32x32x16_bf16 v[84:99], v[28:31], v[160:163], v[84:99]
    ds_read_b64_tr_b16 v[28:29], v12 offset:24576
    ds_read_b64_tr_b16 v[30:31], v13 offset:24576
    s_waitcnt lgkmcnt(6)
    v_mfma_f32_32x32x16_bf16 v[100:115], v[32:35], v[160:163], v[100:115]
    s_waitcnt vmcnt(9)
    s_barrier
    s_add_u32 m0, s58, 16384
    s_nop 0
    buffer_load_dwordx4 v3, s[60:63], s44 offen lds
    s_add_u32 s44, s44, s49
    s_add_u32 m0, s58, 49152
    s_nop 0
    buffer_load_dwordx4 v4, s[64:67], s45 offen lds
    s_add_u32 s45, s45, s50
    s_add_u32 m0, s58, 81920
    s_nop 0
    buffer_load_dwordx4 v5, s[68:71], s46 offen lds
    s_add_u32 s46, s46, s51
    s_add_u32 m0, s58, 114688
    s_nop 0
    buffer_load_dwordx4 v6, s[72:75], s47 offen lds
    s_add_u32 s47, s47, s52
    s_add_u32 m0, s58, 147456
    s_nop 0
    buffer_load_dwordx4 v7, s[76:79], s48 offen lds
    s_add_u32 s48, s48, s53
    s_add_u32 s54, s92, 4096
    buffer_load_dwordx4 v[228:231], v2, s[88:91], s54 offen
    s_add_u32 s54, s92, 5120
    buffer_load_dwordx4 v[232:235], v2, s[88:91], s54 offen
    ds_read_b64_tr_b16 v[32:33], v14 offset:24576
    ds_read_b64_tr_b16 v[34:35], v15 offset:24576
    s_waitcnt lgkmcnt(6)
    v_mfma_f32_32x32x16_bf16 v[36:51], v[20:23], v[164:167], v[36:51]
    ds_read_b64_tr_b16 v[20:21], v16 offset:24576
    ds_read_b64_tr_b16 v[22:23], v17 offset:24576
    s_waitcnt lgkmcnt(6)
    v_mfma_f32_32x32x16_bf16 v[52:67], v[24:27], v[164:167], v[52:67]
    ds_read_b64_tr_b16 v[24:25], v8 offset:26624
    ds_read_b64_tr_b16 v[26:27], v9 offset:26624
    s_waitcnt lgkmcnt(6)
    v_mfma_f32_32x32x16_bf16 v[68:83], v[28:31], v[164:167], v[68:83]
    ds_read_b64_tr_b16 v[28:29], v10 offset:26624
    ds_read_b64_tr_b16 v[30:31], v11 offset:26624
    s_waitcnt lgkmcnt(6)
    v_mfma_f32_32x32x16_bf16 v[84:99], v[32:35], v[164:167], v[84:99]
    ds_read_b64_tr_b16 v[32:33], v12 offset:26624
    ds_read_b64_tr_b16 v[34:35], v13 offset:26624
    s_waitcnt lgkmcnt(6)
    v_mfma_f32_32x32x16_bf16 v[100:115], v[20:23], v[164:167], v[100:115]
    ds_read_b64_tr_b16 v[20:21], v14 offset:26624
    ds_read_b64_tr_b16 v[22:23], v15 offset:26624
    s_waitcnt lgkmcnt(6)
    v_mfma_f32_32x32x16_bf16 v[36:51], v[24:27], v[168:171], v[36:51]
    ds_read_b64_tr_b16 v[24:25], v16 offset:26624
    ds_read_b64_tr_b16 v[26:27], v17 offset:26624
    s_waitcnt lgkmcnt(6)
    v_mfma_f32_32x32x16_bf16 v[52:67], v[28:31], v[168:171], v[52:67]
    ds_read_b64_tr_b16 v[28:29], v8 offset:28672
    ds_read_b64_tr_b16 v[30:31], v9 offset:28672
    s_waitcnt lgkmcnt(6)
    v_mfma_f32_32x32x16_bf16 v[68:83], v[32:35], v[168:171], v[68:83]
    ds_read_b64_tr_b16 v[32:33], v10 offset:28672
    ds_read_b64_tr_b16 v[34:35], v11 offset:28672
    s_waitcnt lgkmcnt(6)
    v_mfma_f32_32x32x16_bf16 v[84:99], v[20:23], v[168:171], v[84:99]
    ds_read_b64_tr_b16 v[20:21], v12 offset:28672
    ds_read_b64_tr_b16 v[22:23], v13 offset:28672
    s_waitcnt lgkmcnt(6)
    v_mfma_f32_32x32x16_bf16 v[100:115], v[24:27], v[168:171], v[100:115]
    ds_read_b64_tr_b16 v[24:25], v14 offset:28672
    ds_read_b64_tr_b16 v[26:27], v15 offset:28672
    s_waitcnt lgkmcnt(6)
    v_mfma_f32_32x32x16_bf16 v[36:51], v[28:31], v[172:175], v[36:51]
    ds_read_b64_tr_b16 v[28:29], v16 offset:28672
    ds_read_b64_tr_b16 v[30:31], v17 offset:28672
    s_waitcnt lgkmcnt(6)
    v_mfma_f32_32x32x16_bf16 v[52:67], v[32:35], v[172:175], v[52:67]
    ds_read_b64_tr_b16 v[32:33], v8 offset:30720
    ds_read_b64_tr_b16 v[34:35], v9 offset:30720
    s_waitcnt lgkmcnt(6)
    v_mfma_f32_32x32x16_bf16 v[68:83], v[20:23], v[172:175], v[68:83]
    ds_read_b64_tr_b16 v[20:21], v10 offset:30720
    ds_read_b64_tr_b16 v[22:23], v11 offset:30720
    s_waitcnt lgkmcnt(6)
    v_mfma_f32_32x32x16_bf16 v[84:99], v[24:27], v[172:175], v[84:99]
    ds_read_b64_tr_b16 v[24:25], v12 offset:30720
    ds_read_b64_tr_b16 v[26:27], v13 offset:30720
    s_waitcnt lgkmcnt(6)
    v_mfma_f32_32x32x16_bf16 v[100:115], v[28:31], v[172:175], v[100:115]
    ds_read_b64_tr_b16 v[28:29], v14 offset:30720
    ds_read_b64_tr_b16 v[30:31], v15 offset:30720
    s_waitcnt lgkmcnt(6)
    v_mfma_f32_32x32x16_bf16 v[36:51], v[32:35], v[176:179], v[36:51]
    ds_read_b64_tr_b16 v[32:33], v16 offset:30720
    ds_read_b64_tr_b16 v[34:35], v17 offset:30720
    s_waitcnt lgkmcnt(6)
    v_mfma_f32_32x32x16_bf16 v[52:67], v[20:23], v[176:179], v[52:67]
    ds_read_b64_tr_b16 v[20:21], v8 offset:0
    ds_read_b64_tr_b16 v[22:23], v9 offset:0
    s_waitcnt lgkmcnt(6)
    v_mfma_f32_32x32x16_bf16 v[68:83], v[24:27], v[176:179], v[68:83]
    ds_read_b64_tr_b16 v[24:25], v10 offset:0
    ds_read_b64_tr_b16 v[26:27], v11 offset:0
    s_waitcnt lgkmcnt(6)
    v_mfma_f32_32x32x16_bf16 v[84:99], v[28:31], v[176:179], v[84:99]
    ds_read_b64_tr_b16 v[28:29], v12 offset:0
    ds_read_b64_tr_b16 v[30:31], v13 offset:0
    s_waitcnt lgkmcnt(6)
    v_mfma_f32_32x32x16_bf16 v[100:115], v[32:35], v[176:179], v[100:115]
    s_waitcnt vmcnt(9)
    s_barrier
    s_add_u32 s54, s92, 6144
    buffer_load_dwordx4 v[228:231], v2, s[88:91], s54 offen
    s_add_u32 s54, s92, 7168
    buffer_load_dwordx4 v[232:235], v2, s[88:91], s54 offen
    ds_read_b64_tr_b16 v[32:33], v14 offset:0
    ds_read_b64_tr_b16 v[34:35], v15 offset:0
    s_waitcnt lgkmcnt(6)
    v_mfma_f32_32x32x16_bf16 v[36:51], v[20:23], v[180:183], v[36:51]
    ds_read_b64_tr_b16 v[20:21], v16 offset:0
    ds_read_b64_tr_b16 v[22:23], v17 offset:0
    s_waitcnt lgkmcnt(6)
    v_mfma_f32_32x32x16_bf16 v[52:67], v[24:27], v[180:183], v[52:67]
    ds_read_b64_tr_b16 v[24:25], v8 offset:2048
    ds_read_b64_tr_b16 v[26:27], v9 offset:2048
    s_waitcnt lgkmcnt(6)
    v_mfma_f32_32x32x16_bf16 v[68:83], v[28:31], v[180:183], v[68:83]
    ds_read_b64_tr_b16 v[28:29], v10 offset:2048
    ds_read_b64_tr_b16 v[30:31], v11 offset:2048
    s_waitcnt lgkmcnt(6)
    v_mfma_f32_32x32x16_bf16 v[84:99], v[32:35], v[180:183], v[84:99]
    ds_read_b64_tr_b16 v[32:33], v12 offset:2048
    ds_read_b64_tr_b16 v[34:35], v13 offset:2048
    s_waitcnt lgkmcnt(6)
    v_mfma_f32_32x32x16_bf16 v[100:115], v[20:23], v[180:183], v[100:115]
    ds_read_b64_tr_b16 v[20:21], v14 offset:2048
    ds_read_b64_tr_b16 v[22:23], v15 offset:2048
    s_waitcnt lgkmcnt(6)
    v_mfma_f32_32x32x16_bf16 v[36:51], v[24:27], v[184:187], v[36:51]
    ds_read_b64_tr_b16 v[24:25], v16 offset:2048
    ds_read_b64_tr_b16 v[26:27], v17 offset:2048
    s_waitcnt lgkmcnt(6)
    v_mfma_f32_32x32x16_bf16 v[52:67], v[28:31], v[184:187], v[52:67]
    ds_read_b64_tr_b16 v[28:29], v8 offset:4096
    ds_read_b64_tr_b16 v[30:31], v9 offset:4096
    s_waitcnt lgkmcnt(6)
    v_mfma_f32_32x32x16_bf16 v[68:83], v[32:35], v[184:187], v[68:83]
    ds_read_b64_tr_b16 v[32:33], v10 offset:4096
    ds_read_b64_tr_b16 v[34:35], v11 offset:4096
    s_waitcnt lgkmcnt(6)
    v_mfma_f32_32x32x16_bf16 v[84:99], v[20:23], v[184:187], v[84:99]
    ds_read_b64_tr_b16 v[20:21], v12 offset:4096
    ds_read_b64_tr_b16 v[22:23], v13 offset:4096
    s_waitcnt lgkmcnt(6)
    v_mfma_f32_32x32x16_bf16 v[100:115], v[24:27], v[184:187], v[100:115]
    ds_read_b64_tr_b16 v[24:25], v14 offset:4096
    ds_read_b64_tr_b16 v[26:27], v15 offset:4096
    s_waitcnt lgkmcnt(6)
    v_mfma_f32_32x32x16_bf16 v[36:51], v[28:31], v[188:191], v[36:51]
    ds_read_b64_tr_b16 v[28:29], v16 offset:4096
    ds_read_b64_tr_b16 v[30:31], v17 offset:4096
    s_waitcnt lgkmcnt(6)
    v_mfma_f32_32x32x16_bf16 v[52:67], v[32:35], v[188:191], v[52:67]
    ds_read_b64_tr_b16 v[32:33], v8 offset:6144
    ds_read_b64_tr_b16 v[34:35], v9 offset:6144
    s_waitcnt lgkmcnt(6)
    v_mfma_f32_32x32x16_bf16 v[68:83], v[20:23], v[188:191], v[68:83]
    ds_read_b64_tr_b16 v[20:21], v10 offset:6144
    ds_read_b64_tr_b16 v[22:23], v11 offset:6144
    s_waitcnt lgkmcnt(6)
    v_mfma_f32_32x32x16_bf16 v[84:99], v[24:27], v[188:191], v[84:99]
    ds_read_b64_tr_b16 v[24:25], v12 offset:6144
    ds_read_b64_tr_b16 v[26:27], v13 offset:6144
    s_waitcnt lgkmcnt(6)
    v_mfma_f32_32x32x16_bf16 v[100:115], v[28:31], v[188:191], v[100:115]
    ds_read_b64_tr_b16 v[28:29], v14 offset:6144
    ds_read_b64_tr_b16 v[30:31], v15 offset:6144
    s_waitcnt lgkmcnt(6)
    v_mfma_f32_32x32x16_bf16 v[36:51], v[32:35], v[192:195], v[36:51]
    ds_read_b64_tr_b16 v[32:33], v16 offset:6144
    ds_read_b64_tr_b16 v[34:35], v17 offset:6144
    s_waitcnt lgkmcnt(6)
    v_mfma_f32_32x32x16_bf16 v[52:67], v[20:23], v[192:195], v[52:67]
    ds_read_b64_tr_b16 v[20:21], v8 offset:8192
    ds_read_b64_tr_b16 v[22:23], v9 offset:8192
    s_waitcnt lgkmcnt(6)
    v_mfma_f32_32x32x16_bf16 v[68:83], v[24:27], v[192:195], v[68:83]
    ds_read_b64_tr_b16 v[24:25], v10 offset:8192
    ds_read_b64_tr_b16 v[26:27], v11 offset:8192
    s_waitcnt lgkmcnt(6)
    v_mfma_f32_32x32x16_bf16 v[84:99], v[28:31], v[192:195], v[84:99]
    ds_read_b64_tr_b16 v[28:29], v12 offset:8192
    ds_read_b64_tr_b16 v[30:31], v13 offset:8192
    s_waitcnt lgkmcnt(6)
    v_mfma_f32_32x32x16_bf16 v[100:115], v[32:35], v[192:195], v[100:115]
    s_waitcnt vmcnt(4)
    s_barrier
    ds_read_b64_tr_b16 v[32:33], v14 offset:8192
    ds_read_b64_tr_b16 v[34:35], v15 offset:8192
    s_waitcnt lgkmcnt(6)
    v_mfma_f32_32x32x16_bf16 v[36:51], v[20:23], v[196:199], v[36:51]
    ds_read_b64_tr_b16 v[20:21], v16 offset:8192
    ds_read_b64_tr_b16 v[22:23], v17 offset:8192
    s_waitcnt lgkmcnt(6)
    v_mfma_f32_32x32x16_bf16 v[52:67], v[24:27], v[196:199], v[52:67]
    ds_read_b64_tr_b16 v[24:25], v8 offset:10240
    ds_read_b64_tr_b16 v[26:27], v9 offset:10240
    s_waitcnt lgkmcnt(6)
    v_mfma_f32_32x32x16_bf16 v[68:83], v[28:31], v[196:199], v[68:83]
    ds_read_b64_tr_b16 v[28:29], v10 offset:10240
    ds_read_b64_tr_b16 v[30:31], v11 offset:10240
    s_waitcnt lgkmcnt(6)
    v_mfma_f32_32x32x16_bf16 v[84:99], v[32:35], v[196:199], v[84:99]
    ds_read_b64_tr_b16 v[32:33], v12 offset:10240
    ds_read_b64_tr_b16 v[34:35], v13 offset:10240
    s_waitcnt lgkmcnt(6)
    v_mfma_f32_32x32x16_bf16 v[100:115], v[20:23], v[196:199], v[100:115]
    ds_read_b64_tr_b16 v[20:21], v14 offset:10240
    ds_read_b64_tr_b16 v[22:23], v15 offset:10240
    s_waitcnt lgkmcnt(6)
    v_mfma_f32_32x32x16_bf16 v[36:51], v[24:27], v[200:203], v[36:51]
    ds_read_b64_tr_b16 v[24:25], v16 offset:10240
    ds_read_b64_tr_b16 v[26:27], v17 offset:10240
    s_waitcnt lgkmcnt(6)
    v_mfma_f32_32x32x16_bf16 v[52:67], v[28:31], v[200:203], v[52:67]
    ds_read_b64_tr_b16 v[28:29], v8 offset:12288
    ds_read_b64_tr_b16 v[30:31], v9 offset:12288
    s_waitcnt lgkmcnt(6)
    v_mfma_f32_32x32x16_bf16 v[68:83], v[32:35], v[200:203], v[68:83]
    ds_read_b64_tr_b16 v[32:33], v10 offset:12288
    ds_read_b64_tr_b16 v[34:35], v11 offset:12288
    s_waitcnt lgkmcnt(6)
    v_mfma_f32_32x32x16_bf16 v[84:99], v[20:23], v[200:203], v[84:99]
    ds_read_b64_tr_b16 v[20:21], v12 offset:12288
    ds_read_b64_tr_b16 v[22:23], v13 offset:12288
    s_waitcnt lgkmcnt(6)
    v_mfma_f32_32x32x16_bf16 v[100:115], v[24:27], v[200:203], v[100:115]
    ds_read_b64_tr_b16 v[24:25], v14 offset:12288
    ds_read_b64_tr_b16 v[26:27], v15 offset:12288
    s_waitcnt lgkmcnt(6)
    v_mfma_f32_32x32x16_bf16 v[36:51], v[28:31], v[204:207], v[36:51]
    ds_read_b64_tr_b16 v[28:29], v16 offset:12288
    ds_read_b64_tr_b16 v[30:31], v17 offset:12288
    s_waitcnt lgkmcnt(6)
    v_mfma_f32_32x32x16_bf16 v[52:67], v[32:35], v[204:207], v[52:67]
    ds_read_b64_tr_b16 v[32:33], v8 offset:14336
    ds_read_b64_tr_b16 v[34:35], v9 offset:14336
    s_waitcnt lgkmcnt(6)
    v_mfma_f32_32x32x16_bf16 v[68:83], v[20:23], v[204:207], v[68:83]
    ds_read_b64_tr_b16 v[20:21], v10 offset:14336
    ds_read_b64_tr_b16 v[22:23], v11 offset:14336
    s_waitcnt lgkmcnt(6)
    v_mfma_f32_32x32x16_bf16 v[84:99], v[24:27], v[204:207], v[84:99]
    ds_read_b64_tr_b16 v[24:25], v12 offset:14336
    ds_read_b64_tr_b16 v[26:27], v13 offset:14336
    s_waitcnt lgkmcnt(6)
    v_mfma_f32_32x32x16_bf16 v[100:115], v[28:31], v[204:207], v[100:115]
    ds_read_b64_tr_b16 v[28:29], v14 offset:14336
    ds_read_b64_tr_b16 v[30:31], v15 offset:14336
    s_waitcnt lgkmcnt(6)
    v_mfma_f32_32x32x16_bf16 v[36:51], v[32:35], v[208:211], v[36:51]
    ds_read_b64_tr_b16 v[32:33], v16 offset:14336
    ds_read_b64_tr_b16 v[34:35], v17 offset:14336
    s_waitcnt lgkmcnt(6)
    v_mfma_f32_32x32x16_bf16 v[52:67], v[20:23], v[208:211], v[52:67]
    ds_read_b64_tr_b16 v[20:21], v8 offset:16384
    ds_read_b64_tr_b16 v[22:23], v9 offset:16384
    s_waitcnt lgkmcnt(6)
    v_mfma_f32_32x32x16_bf16 v[68:83], v[24:27], v[208:211], v[68:83]
    ds_read_b64_tr_b16 v[24:25], v10 offset:16384
    ds_read_b64_tr_b16 v[26:27], v11 offset:16384
    s_waitcnt lgkmcnt(6)
    v_mfma_f32_32x32x16_bf16 v[84:99], v[28:31], v[208:211], v[84:99]
    ds_read_b64_tr_b16 v[28:29], v12 offset:16384
    ds_read_b64_tr_b16 v[30:31], v13 offset:16384
    s_waitcnt lgkmcnt(6)
    v_mfma_f32_32x32x16_bf16 v[100:115], v[32:35], v[208:211], v[100:115]
    s_waitcnt vmcnt(4)
    s_barrier
    ds_read_b64_tr_b16 v[32:33], v14 offset:16384
    ds_read_b64_tr_b16 v[34:35], v15 offset:16384
    s_waitcnt lgkmcnt(6)
    v_mfma_f32_32x32x16_bf16 v[36:51], v[20:23], v[212:215], v[36:51]
    ds_read_b64_tr_b16 v[20:21], v16 offset:16384
    ds_read_b64_tr_b16 v[22:23], v17 offset:16384
    s_waitcnt lgkmcnt(6)
    v_mfma_f32_32x32x16_bf16 v[52:67], v[24:27], v[212:215], v[52:67]
    ds_read_b64_tr_b16 v[24:25], v8 offset:18432
    ds_read_b64_tr_b16 v[26:27], v9 offset:18432
    s_waitcnt lgkmcnt(6)
    v_mfma_f32_32x32x16_bf16 v[68:83], v[28:31], v[212:215], v[68:83]
    ds_read_b64_tr_b16 v[28:29], v10 offset:18432
    ds_read_b64_tr_b16 v[30:31], v11 offset:18432
    s_waitcnt lgkmcnt(6)
    v_mfma_f32_32x32x16_bf16 v[84:99], v[32:35], v[212:215], v[84:99]
    ds_read_b64_tr_b16 v[32:33], v12 offset:18432
    ds_read_b64_tr_b16 v[34:35], v13 offset:18432
    s_waitcnt lgkmcnt(6)
    v_mfma_f32_32x32x16_bf16 v[100:115], v[20:23], v[212:215], v[100:115]
    ds_read_b64_tr_b16 v[20:21], v14 offset:18432
    ds_read_b64_tr_b16 v[22:23], v15 offset:18432
    s_waitcnt lgkmcnt(6)
    v_mfma_f32_32x32x16_bf16 v[36:51], v[24:27], v[216:219], v[36:51]
    ds_read_b64_tr_b16 v[24:25], v16 offset:18432
    ds_read_b64_tr_b16 v[26:27], v17 offset:18432
    s_waitcnt lgkmcnt(6)
    v_mfma_f32_32x32x16_bf16 v[52:67], v[28:31], v[216:219], v[52:67]
    ds_read_b64_tr_b16 v[28:29], v8 offset:20480
    ds_read_b64_tr_b16 v[30:31], v9 offset:20480
    s_waitcnt lgkmcnt(6)
    v_mfma_f32_32x32x16_bf16 v[68:83], v[32:35], v[216:219], v[68:83]
    ds_read_b64_tr_b16 v[32:33], v10 offset:20480
    ds_read_b64_tr_b16 v[34:35], v11 offset:20480
    s_waitcnt lgkmcnt(6)
    v_mfma_f32_32x32x16_bf16 v[84:99], v[20:23], v[216:219], v[84:99]
    ds_read_b64_tr_b16 v[20:21], v12 offset:20480
    ds_read_b64_tr_b16 v[22:23], v13 offset:20480
    s_waitcnt lgkmcnt(6)
    v_mfma_f32_32x32x16_bf16 v[100:115], v[24:27], v[216:219], v[100:115]
    ds_read_b64_tr_b16 v[24:25], v14 offset:20480
    ds_read_b64_tr_b16 v[26:27], v15 offset:20480
    s_waitcnt lgkmcnt(6)
    v_mfma_f32_32x32x16_bf16 v[36:51], v[28:31], v[220:223], v[36:51]
    ds_read_b64_tr_b16 v[28:29], v16 offset:20480
    ds_read_b64_tr_b16 v[30:31], v17 offset:20480
    s_waitcnt lgkmcnt(6)
    v_mfma_f32_32x32x16_bf16 v[52:67], v[32:35], v[220:223], v[52:67]
    ds_read_b64_tr_b16 v[32:33], v8 offset:22528
    ds_read_b64_tr_b16 v[34:35], v9 offset:22528
    s_waitcnt lgkmcnt(6)
    v_mfma_f32_32x32x16_bf16 v[68:83], v[20:23], v[220:223], v[68:83]
    ds_read_b64_tr_b16 v[20:21], v10 offset:22528
    ds_read_b64_tr_b16 v[22:23], v11 offset:22528
    s_waitcnt lgkmcnt(6)
    v_mfma_f32_32x32x16_bf16 v[84:99], v[24:27], v[220:223], v[84:99]
    ds_read_b64_tr_b16 v[24:25], v12 offset:22528
    ds_read_b64_tr_b16 v[26:27], v13 offset:22528
    s_waitcnt lgkmcnt(6)
    v_mfma_f32_32x32x16_bf16 v[100:115], v[28:31], v[220:223], v[100:115]
    ds_read_b64_tr_b16 v[28:29], v14 offset:22528
    ds_read_b64_tr_b16 v[30:31], v15 offset:22528
    s_waitcnt lgkmcnt(6)
    v_mfma_f32_32x32x16_bf16 v[36:51], v[32:35], v[224:227], v[36:51]
    ds_read_b64_tr_b16 v[32:33], v16 offset:22528
    ds_read_b64_tr_b16 v[34:35], v17 offset:22528
    s_waitcnt lgkmcnt(6)
    v_mfma_f32_32x32x16_bf16 v[52:67], v[20:23], v[224:227], v[52:67]
    s_waitcnt lgkmcnt(4)
    v_mfma_f32_32x32x16_bf16 v[68:83], v[24:27], v[224:227], v[68:83]
    s_waitcnt lgkmcnt(2)
    v_mfma_f32_32x32x16_bf16 v[84:99], v[28:31], v[224:227], v[84:99]
    s_waitcnt lgkmcnt(0)
    v_mfma_f32_32x32x16_bf16 v[100:115], v[32:35], v[224:227], v[100:115]
    s_waitcnt vmcnt(0)
    s_add_u32 s54, s37, 0
    s_cmp_lt_u32 s54, 56
    s_cbranch_scc1 K1_EGU0
    s_sub_u32 s54, s54, 56
    s_lshl_b32 s54, s54, 1
    s_add_u32 s54, s54, s34
    s_cmp_ge_u32 s54, 32
    s_cselect_b32 s55, 0x3f80, 0
    v_mov_b32 v236, s55
    s_lshl_b32 s54, s54, 6
    s_add_u32 s54, s54, s38
    s_lshl_b32 s59, s54, 11
    s_nop 4
    v_cvt_pk_bf16_f32 v228, v36, v37
    v_cvt_pk_bf16_f32 v229, v38, v39
    v_cvt_pk_bf16_f32 v230, v40, v41
    v_cvt_pk_bf16_f32 v231, v42, v43
    v_cvt_pk_bf16_f32 v232, v44, v45
    v_cvt_pk_bf16_f32 v233, v46, v47
    v_cvt_pk_bf16_f32 v234, v48, v49
    v_cvt_pk_bf16_f32 v235, v50, v51
    v_cndmask_b32 v234, v234, v236, s[40:41]
    v_cndmask_b32 v235, v235, 0, s[40:41]
    buffer_store_dwordx4 v[228:231], v2, s[20:23], s59 offen sc0 sc1
    buffer_store_dwordx4 v[232:235], v2, s[20:23], s59 offen offset:1024 sc0 sc1
    s_branch K1_EJ0
K1_EGU0:
    s_lshl_b32 s54, s54, 1
    s_add_u32 s54, s54, s34
    s_mul_i32 s55, s38, 112
    s_add_u32 s54, s54, s55
    s_lshl_b32 s59, s54, 10
    s_add_u32 s59, s59, 6291456
    s_nop 6
    v_mul_f32 v36, v36, v44
    v_mul_f32 v37, v37, v45
    v_mul_f32 v38, v38, v46
    v_mul_f32 v39, v39, v47
    v_mul_f32 v40, v40, v48
    v_mul_f32 v41, v41, v49
    v_mul_f32 v42, v42, v50
    v_mul_f32 v43, v43, v51
    v_cvt_pk_bf16_f32 v228, v36, v37
    v_cvt_pk_bf16_f32 v229, v38, v39
    v_cvt_pk_bf16_f32 v230, v40, v41
    v_cvt_pk_bf16_f32 v231, v42, v43
    buffer_store_dwordx4 v[228:231], v2, s[20:23], s59 offen sc0 sc1
K1_EJ0:
    s_add_u32 s54, s37, 1
    s_cmp_lt_u32 s54, 56
    s_cbranch_scc1 K1_EGU1
    s_sub_u32 s54, s54, 56
    s_lshl_b32 s54, s54, 1
    s_add_u32 s54, s54, s34
    s_cmp_ge_u32 s54, 32
    s_cselect_b32 s55, 0x3f80, 0
    v_mov_b32 v236, s55
    s_lshl_b32 s54, s54, 6
    s_add_u32 s54, s54, s38
    s_lshl_b32 s59, s54, 11
    s_nop 4
    v_cvt_pk_bf16_f32 v20, v52, v53
    v_cvt_pk_bf16_f32 v21, v54, v55
    v_cvt_pk_bf16_f32 v22, v56, v57
    v_cvt_pk_bf16_f32 v23, v58, v59
    v_cvt_pk_bf16_f32 v24, v60, v61
    v_cvt_pk_bf16_f32 v25, v62, v63
    v_cvt_pk_bf16_f32 v26, v64, v65
    v_cvt_pk_bf16_f32 v27, v66, v67
    v_cndmask_b32 v26, v26, v236, s[40:41]
    v_cndmask_b32 v27, v27, 0, s[40:41]
    buffer_store_dwordx4 v[20:23], v2, s[20:23], s59 offen sc0 sc1
    buffer_store_dwordx4 v[24:27], v2, s[20:23], s59 offen offset:1024 sc0 sc1
    s_branch K1_EJ1
K1_EGU1:
    s_lshl_b32 s54, s54, 1
    s_add_u32 s54, s54, s34
    s_mul_i32 s55, s38, 112
    s_add_u32 s54, s54, s55
    s_lshl_b32 s59, s54, 10
    s_add_u32 s59, s59, 6291456
    s_nop 6
    v_mul_f32 v52, v52, v60
    v_mul_f32 v53, v53, v61
    v_mul_f32 v54, v54, v62
    v_mul_f32 v55, v55, v63
    v_mul_f32 v56, v56, v64
    v_mul_f32 v57, v57, v65
    v_mul_f32 v58, v58, v66
    v_mul_f32 v59, v59, v67
    v_cvt_pk_bf16_f32 v20, v52, v53
    v_cvt_pk_bf16_f32 v21, v54, v55
    v_cvt_pk_bf16_f32 v22, v56, v57
    v_cvt_pk_bf16_f32 v23, v58, v59
    buffer_store_dwordx4 v[20:23], v2, s[20:23], s59 offen sc0 sc1
K1_EJ1:
    s_add_u32 s54, s37, 2
    s_cmp_lt_u32 s54, 56
    s_cbranch_scc1 K1_EGU2
    s_sub_u32 s54, s54, 56
    s_lshl_b32 s54, s54, 1
    s_add_u32 s54, s54, s34
    s_cmp_ge_u32 s54, 32
    s_cselect_b32 s55, 0x3f80, 0
    v_mov_b32 v236, s55
    s_lshl_b32 s54, s54, 6
    s_add_u32 s54, s54, s38
    s_lshl_b32 s59, s54, 11
    s_nop 4
    v_cvt_pk_bf16_f32 v228, v68, v69
    v_cvt_pk_bf16_f32 v229, v70, v71
    v_cvt_pk_bf16_f32 v230, v72, v73
    v_cvt_pk_bf16_f32 v231, v74, v75
    v_cvt_pk_bf16_f32 v232, v76, v77
    v_cvt_pk_bf16_f32 v233, v78, v79
    v_cvt_pk_bf16_f32 v234, v80, v81
    v_cvt_pk_bf16_f32 v235, v82, v83
    v_cndmask_b32 v234, v234, v236, s[40:41]
    v_cndmask_b32 v235, v235, 0, s[40:41]
    buffer_store_dwordx4 v[228:231], v2, s[20:23], s59 offen sc0 sc1
    buffer_store_dwordx4 v[232:235], v2, s[20:23], s59 offen offset:1024 sc0 sc1
    s_branch K1_EJ2
K1_EGU2:
    s_lshl_b32 s54, s54, 1
    s_add_u32 s54, s54, s34
    s_mul_i32 s55, s38, 112
    s_add_u32 s54, s54, s55
    s_lshl_b32 s59, s54, 10
    s_add_u32 s59, s59, 6291456
    s_nop 6
    v_mul_f32 v68, v68, v76
    v_mul_f32 v69, v69, v77
    v_mul_f32 v70, v70, v78
    v_mul_f32 v71, v71, v79
    v_mul_f32 v72, v72, v80
    v_mul_f32 v73, v73, v81
    v_mul_f32 v74, v74, v82
    v_mul_f32 v75, v75, v83
    v_cvt_pk_bf16_f32 v228, v68, v69
    v_cvt_pk_bf16_f32 v229, v70, v71
    v_cvt_pk_bf16_f32 v230, v72, v73
    v_cvt_pk_bf16_f32 v231, v74, v75
    buffer_store_dwordx4 v[228:231], v2, s[20:23], s59 offen sc0 sc1
K1_EJ2:
    s_add_u32 s54, s37, 3
    s_cmp_lt_u32 s54, 56
    s_cbranch_scc1 K1_EGU3
    s_sub_u32 s54, s54, 56
    s_lshl_b32 s54, s54, 1
    s_add_u32 s54, s54, s34
    s_cmp_ge_u32 s54, 32
    s_cselect_b32 s55, 0x3f80, 0
    v_mov_b32 v236, s55
    s_lshl_b32 s54, s54, 6
    s_add_u32 s54, s54, s38
    s_lshl_b32 s59, s54, 11
    s_nop 4
    v_cvt_pk_bf16_f32 v20, v84, v85
    v_cvt_pk_bf16_f32 v21, v86, v87
    v_cvt_pk_bf16_f32 v22, v88, v89
    v_cvt_pk_bf16_f32 v23, v90, v91
    v_cvt_pk_bf16_f32 v24, v92, v93
    v_cvt_pk_bf16_f32 v25, v94, v95
    v_cvt_pk_bf16_f32 v26, v96, v97
    v_cvt_pk_bf16_f32 v27, v98, v99
    v_cndmask_b32 v26, v26, v236, s[40:41]
    v_cndmask_b32 v27, v27, 0, s[40:41]
    buffer_store_dwordx4 v[20:23], v2, s[20:23], s59 offen sc0 sc1
    buffer_store_dwordx4 v[24:27], v2, s[20:23], s59 offen offset:1024 sc0 sc1
    s_branch K1_EJ3
K1_EGU3:
    s_lshl_b32 s54, s54, 1
    s_add_u32 s54, s54, s34
    s_mul_i32 s55, s38, 112
    s_add_u32 s54, s54, s55
    s_lshl_b32 s59, s54, 10
    s_add_u32 s59, s59, 6291456
    s_nop 6
    v_mul_f32 v84, v84, v92
    v_mul_f32 v85, v85, v93
    v_mul_f32 v86, v86, v94
    v_mul_f32 v87, v87, v95
    v_mul_f32 v88, v88, v96
    v_mul_f32 v89, v89, v97
    v_mul_f32 v90, v90, v98
    v_mul_f32 v91, v91, v99
    v_cvt_pk_bf16_f32 v20, v84, v85
    v_cvt_pk_bf16_f32 v21, v86, v87
    v_cvt_pk_bf16_f32 v22, v88, v89
    v_cvt_pk_bf16_f32 v23, v90, v91
    buffer_store_dwordx4 v[20:23], v2, s[20:23], s59 offen sc0 sc1
K1_EJ3:
    s_add_u32 s54, s37, 4
    s_cmp_lt_u32 s54, 56
    s_cbranch_scc1 K1_EGU4
    s_sub_u32 s54, s54, 56
    s_lshl_b32 s54, s54, 1
    s_add_u32 s54, s54, s34
    s_cmp_ge_u32 s54, 32
    s_cselect_b32 s55, 0x3f80, 0
    v_mov_b32 v236, s55
    s_lshl_b32 s54, s54, 6
    s_add_u32 s54, s54, s38
    s_lshl_b32 s59, s54, 11
    s_nop 4
    v_cvt_pk_bf16_f32 v228, v100, v101
    v_cvt_pk_bf16_f32 v229, v102, v103
    v_cvt_pk_bf16_f32 v230, v104, v105
    v_cvt_pk_bf16_f32 v231, v106, v107
    v_cvt_pk_bf16_f32 v232, v108, v109
    v_cvt_pk_bf16_f32 v233, v110, v111
    v_cvt_pk_bf16_f32 v234, v112, v113
    v_cvt_pk_bf16_f32 v235, v114, v115
    v_cndmask_b32 v234, v234, v236, s[40:41]
    v_cndmask_b32 v235, v235, 0, s[40:41]
    buffer_store_dwordx4 v[228:231], v2, s[20:23], s59 offen sc0 sc1
    buffer_store_dwordx4 v[232:235], v2, s[20:23], s59 offen offset:1024 sc0 sc1
    s_branch K1_EJ4
K1_EGU4:
    s_lshl_b32 s54, s54, 1
    s_add_u32 s54, s54, s34
    s_mul_i32 s55, s38, 112
    s_add_u32 s54, s54, s55
    s_lshl_b32 s59, s54, 10
    s_add_u32 s59, s59, 6291456
    s_nop 6
    v_mul_f32 v100, v100, v108
    v_mul_f32 v101, v101, v109
    v_mul_f32 v102, v102, v110
    v_mul_f32 v103, v103, v111
    v_mul_f32 v104, v104, v112
    v_mul_f32 v105, v105, v113
    v_mul_f32 v106, v106, v114
    v_mul_f32 v107, v107, v115
    v_cvt_pk_bf16_f32 v228, v100, v101
    v_cvt_pk_bf16_f32 v229, v102, v103
    v_cvt_pk_bf16_f32 v230, v104, v105
    v_cvt_pk_bf16_f32 v231, v106, v107
    buffer_store_dwordx4 v[228:231], v2, s[20:23], s59 offen sc0 sc1
K1_EJ4:
    s_waitcnt vmcnt(0)
    s_barrier
    s_cmp_lg_u32 s3, 0
    s_cbranch_scc1 K1_PUBD
    s_load_dwordx2 s[88:89], s[0:1], 64
    s_waitcnt lgkmcnt(0)
    s_mov_b32 s90, 256
    s_mov_b32 s91, 0x00020000
    v_mov_b32 v241, 0
K1_INITP:
    buffer_load_dword v240, v241, s[88:91], 0 offen sc0 sc1
    s_waitcnt vmcnt(0)
    v_readfirstlane_b32 s92, v240
    s_nop 0
    s_cmp_lg_u32 s92, 0
    s_cbranch_scc1 K1_INITOK
    s_sleep 8
    s_branch K1_INITP
K1_INITOK:
    s_lshl_b32 s92, s35, 7
    s_add_u32 s92, s92, 0xF02000
    v_mov_b32 v240, 1
    s_mov_b64 exec, 1
    s_cmp_gt_u32 s36, 11
    s_cbranch_scc1 K1_NOH
    buffer_atomic_add v240, v241, s[20:23], s92 offen sc1
K1_NOH:
    s_cmp_lt_u32 s36, 11
    s_cbranch_scc1 K1_NOQ
    s_add_u32 s92, s92, 2048
    buffer_atomic_add v240, v241, s[20:23], s92 offen sc1
K1_NOQ:
    s_mov_b64 exec, -1
K1_PUBD:
    s_load_dwordx2 s[10:11], s[0:1], 72
    s_load_dwordx2 s[14:15], s[0:1], 48
    s_load_dwordx2 s[16:17], s[0:1], 16
    s_load_dwordx2 s[18:19], s[0:1], 0
    s_load_dwordx2 s[56:57], s[0:1], 56
    v_and_b32 v1, 63, v0
    v_lshrrev_b32 v6, 6, v0
    v_lshlrev_b32 v2, 4, v1
    v_readfirstlane_b32 s3, v6
    v_mov_b32 v6, 131072
    v_mov_b32 v8, 0
    v_mov_b32 v9, 0
    v_mov_b32 v10, 0
    v_mov_b32 v11, 0
    ds_write_b128 v6, v[8:11]
    s_and_b32 s36, s2, 7
    s_lshr_b32 s37, s2, 3
    s_lshl_b32 s52, s36, 2
    s_and_b32 s38, s37, 3
    s_add_u32 s52, s52, s38
    s_lshr_b32 s53, s37, 2
    s_waitcnt lgkmcnt(0)
    s_barrier
    s_mov_b32 s97, s3
    s_cmp_lt_u32 s3, 4
    s_cbranch_scc1 K23_ATT
    s_sub_u32 s3, s3, 4
    s_lshl_b32 s42, s3, 14
    s_add_u32 s42, s42, 65536
    v_bfe_u32 v8, v1, 2, 2
    v_and_b32 v9, 3, v1
    v_bfe_u32 v10, v1, 4, 1
    v_lshrrev_b32 v11, 5, v1
    v_lshl_add_u32 v12, v10, 2, v9
    v_and_b32 v13, 1, v12
    v_lshlrev_b32 v13, 2, v13
    v_lshrrev_b32 v14, 1, v12
    v_or_b32 v13, v13, v14
    v_lshlrev_b32 v13, 3, v13
    v_bfe_u32 v15, v8, 1, 1
    v_lshlrev_b32 v15, 6, v15
    v_xor_b32 v13, v13, v15
    v_lshl_add_u32 v14, v11, 3, v8
    v_lshl_add_u32 v13, v14, 7, v13
    v_add_u32 v4, s42, v13
    v_add_u32 v5, 512, v4
    v_xor_b32 v6, 64, v4
    v_xor_b32 v7, 64, v5
    v_lshrrev_b32 v13, 3, v1
    v_and_b32 v14, 7, v1
    v_bfe_u32 v15, v1, 4, 1
    v_lshlrev_b32 v15, 2, v15
    v_xor_b32 v14, v14, v15
    v_lshlrev_b32 v14, 4, v14
    s_movk_i32 s36, 896
    v_mad_u32_u24 v3, v13, s36, v14
    s_waitcnt lgkmcnt(0)
    s_cmp_ge_u32 s53, 7
    s_cbranch_scc1 K23_END0
    s_mov_b32 s4, s10
    s_mov_b32 s5, s11
    s_mov_b32 s6, 268435456
    s_mov_b32 s7, 0x00020000
    s_mov_b32 s8, s14
    s_mov_b32 s9, s15
    s_mov_b32 s10, 1605632
    s_mov_b32 s11, 0x00020000
    s_mul_i32 s40, s3, 401408
    s_lshl_b32 s36, s53, 7
    s_add_u32 s40, s40, s36
    s_lshl_b32 s37, s52, 1
    s_mul_i32 s41, s37, 112
    s_mul_i32 s38, s3, 28
    s_add_u32 s41, s41, s38
    s_lshl_b32 s41, s41, 10
    s_add_u32 s41, s41, 6291456
    s_add_u32 m0, s42, 0
    s_add_u32 s36, s40, 7168
    buffer_load_dwordx4 v3, s[8:11], s40 offen lds
    s_add_u32 m0, s42, 1024
    s_nop 0
    buffer_load_dwordx4 v3, s[8:11], s36 offen lds
    s_add_u32 s40, s40, 14336
    s_add_u32 m0, s42, 2048
    s_add_u32 s36, s40, 7168
    buffer_load_dwordx4 v3, s[8:11], s40 offen lds
    s_add_u32 m0, s42, 3072
    s_nop 0
    buffer_load_dwordx4 v3, s[8:11], s36 offen lds
    s_add_u32 s40, s40, 14336
    s_add_u32 m0, s42, 4096
    s_add_u32 s36, s40, 7168
    buffer_load_dwordx4 v3, s[8:11], s40 offen lds
    s_add_u32 m0, s42, 5120
    s_nop 0
    buffer_load_dwordx4 v3, s[8:11], s36 offen lds
    s_add_u32 s40, s40, 14336
    s_add_u32 m0, s42, 6144
    s_add_u32 s36, s40, 7168
    buffer_load_dwordx4 v3, s[8:11], s40 offen lds
    s_add_u32 m0, s42, 7168
    s_nop 0
    buffer_load_dwordx4 v3, s[8:11], s36 offen lds
    s_add_u32 s40, s40, 14336
    s_add_u32 m0, s42, 8192
    s_add_u32 s36, s40, 7168
    buffer_load_dwordx4 v3, s[8:11], s40 offen lds
    s_add_u32 m0, s42, 9216
    s_nop 0
    buffer_load_dwordx4 v3, s[8:11], s36 offen lds
    s_add_u32 s40, s40, 14336
    v_mov_b32 v8, 131072
    s_cmp_lg_u32 s3, 0
    s_cbranch_scc1 K23_HW
    s_lshr_b32 s36, s52, 1
    s_lshl_b32 s36, s36, 7
    s_add_u32 s36, s36, 0xF02000
    v_mov_b32 v9, 0
K23_HP:
    buffer_load_dword v10, v9, s[4:7], s36 offen sc0 sc1
    s_waitcnt vmcnt(0)
    v_readfirstlane_b32 s37, v10
    s_nop 0
    s_cmp_ge_u32 s37, 12
    s_cbranch_scc1 K23_HOK
    s_sleep 4
    s_branch K23_HP
K23_HOK:
    v_mov_b32 v9, 1
    ds_write_b32 v8, v9 offset:12
    s_branch K23_HGO
K23_HW:
    ds_read_b32 v9, v8 offset:12
    s_waitcnt lgkmcnt(0)
    v_readfirstlane_b32 s36, v9
    s_nop 0
    s_cmp_lg_u32 s36, 0
    s_cbranch_scc1 K23_HGO
    s_sleep 2
    s_branch K23_HW
K23_HGO:
    buffer_load_dwordx4 v[32:35], v2, s[4:7], s41 offen sc0 sc1
    s_add_u32 s36, s41, 114688
    buffer_load_dwordx4 v[36:39], v2, s[4:7], s36 offen sc0 sc1
    s_add_u32 s41, s41, 1024
    buffer_load_dwordx4 v[40:43], v2, s[4:7], s41 offen sc0 sc1
    s_add_u32 s36, s41, 114688
    buffer_load_dwordx4 v[44:47], v2, s[4:7], s36 offen sc0 sc1
    s_add_u32 s41, s41, 1024
    buffer_load_dwordx4 v[48:51], v2, s[4:7], s41 offen sc0 sc1
    s_add_u32 s36, s41, 114688
    buffer_load_dwordx4 v[52:55], v2, s[4:7], s36 offen sc0 sc1
    s_add_u32 s41, s41, 1024
    buffer_load_dwordx4 v[56:59], v2, s[4:7], s41 offen sc0 sc1
    s_add_u32 s36, s41, 114688
    buffer_load_dwordx4 v[60:63], v2, s[4:7], s36 offen sc0 sc1
    s_add_u32 s41, s41, 1024
    buffer_load_dwordx4 v[64:67], v2, s[4:7], s41 offen sc0 sc1
    s_add_u32 s36, s41, 114688
    buffer_load_dwordx4 v[68:71], v2, s[4:7], s36 offen sc0 sc1
    s_add_u32 s41, s41, 1024
    buffer_load_dwordx4 v[72:75], v2, s[4:7], s41 offen sc0 sc1
    s_add_u32 s36, s41, 114688
    buffer_load_dwordx4 v[76:79], v2, s[4:7], s36 offen sc0 sc1
    s_add_u32 s41, s41, 1024
    buffer_load_dwordx4 v[80:83], v2, s[4:7], s41 offen sc0 sc1
    s_add_u32 s36, s41, 114688
    buffer_load_dwordx4 v[84:87], v2, s[4:7], s36 offen sc0 sc1
    s_add_u32 s41, s41, 1024
    buffer_load_dwordx4 v[88:91], v2, s[4:7], s41 offen sc0 sc1
    s_add_u32 s36, s41, 114688
    buffer_load_dwordx4 v[92:95], v2, s[4:7], s36 offen sc0 sc1
    s_add_u32 s41, s41, 1024
    buffer_load_dwordx4 v[96:99], v2, s[4:7], s41 offen sc0 sc1
    s_add_u32 s36, s41, 114688
    buffer_load_dwordx4 v[100:103], v2, s[4:7], s36 offen sc0 sc1
    s_add_u32 s41, s41, 1024
    buffer_load_dwordx4 v[104:107], v2, s[4:7], s41 offen sc0 sc1
    s_add_u32 s36, s41, 114688
    buffer_load_dwordx4 v[108:111], v2, s[4:7], s36 offen sc0 sc1
    s_add_u32 s41, s41, 1024
    buffer_load_dwordx4 v[112:115], v2, s[4:7], s41 offen sc0 sc1
    s_add_u32 s36, s41, 114688
    buffer_load_dwordx4 v[116:119], v2, s[4:7], s36 offen sc0 sc1
    s_add_u32 s41, s41, 1024
    s_waitcnt vmcnt(30)
    ds_read_b64_tr_b16 v[16:17], v4 offset:0
    ds_read_b64_tr_b16 v[18:19], v5 offset:0
    ds_read_b64_tr_b16 v[20:21], v6 offset:0
    ds_read_b64_tr_b16 v[22:23], v7 offset:0
    buffer_load_dwordx4 v[120:123], v2, s[4:7], s41 offen sc0 sc1
    s_add_u32 s36, s41, 114688
    buffer_load_dwordx4 v[124:127], v2, s[4:7], s36 offen sc0 sc1
    s_add_u32 s41, s41, 1024
    s_add_u32 m0, s42, 10240
    s_add_u32 s36, s40, 7168
    buffer_load_dwordx4 v3, s[8:11], s40 offen lds
    s_add_u32 m0, s42, 11264
    s_nop 0
    buffer_load_dwordx4 v3, s[8:11], s36 offen lds
    s_add_u32 s40, s40, 14336
    s_waitcnt vmcnt(24)
    ds_read_b64_tr_b16 v[24:25], v4 offset:2048
    ds_read_b64_tr_b16 v[26:27], v5 offset:2048
    ds_read_b64_tr_b16 v[28:29], v6 offset:2048
    ds_read_b64_tr_b16 v[30:31], v7 offset:2048
    s_waitcnt lgkmcnt(4)
    v_mfma_f32_32x32x16_bf16 v[128:143], v[16:19], v[32:35], 0
    v_mfma_f32_32x32x16_bf16 v[144:159], v[20:23], v[32:35], 0
    v_mfma_f32_32x32x16_bf16 v[160:175], v[16:19], v[36:39], 0
    v_mfma_f32_32x32x16_bf16 v[176:191], v[20:23], v[36:39], 0
    buffer_load_dwordx4 v[32:35], v2, s[4:7], s41 offen sc0 sc1
    s_add_u32 s36, s41, 114688
    buffer_load_dwordx4 v[36:39], v2, s[4:7], s36 offen sc0 sc1
    s_add_u32 s41, s41, 1024
    s_add_u32 m0, s42, 0
    s_add_u32 s36, s40, 7168
    buffer_load_dwordx4 v3, s[8:11], s40 offen lds
    s_add_u32 m0, s42, 1024
    s_nop 0
    buffer_load_dwordx4 v3, s[8:11], s36 offen lds
    s_add_u32 s40, s40, 14336
    s_waitcnt vmcnt(26)
    ds_read_b64_tr_b16 v[16:17], v4 offset:4096
    ds_read_b64_tr_b16 v[18:19], v5 offset:4096
    ds_read_b64_tr_b16 v[20:21], v6 offset:4096
    ds_read_b64_tr_b16 v[22:23], v7 offset:4096
    s_waitcnt lgkmcnt(4)
    v_mfma_f32_32x32x16_bf16 v[128:143], v[24:27], v[40:43], v[128:143]
    v_mfma_f32_32x32x16_bf16 v[144:159], v[28:31], v[40:43], v[144:159]
    v_mfma_f32_32x32x16_bf16 v[160:175], v[24:27], v[44:47], v[160:175]
    v_mfma_f32_32x32x16_bf16 v[176:191], v[28:31], v[44:47], v[176:191]
    buffer_load_dwordx4 v[40:43], v2, s[4:7], s41 offen sc0 sc1
    s_add_u32 s36, s41, 114688
    buffer_load_dwordx4 v[44:47], v2, s[4:7], s36 offen sc0 sc1
    s_add_u32 s41, s41, 1024
    s_add_u32 m0, s42, 2048
    s_add_u32 s36, s40, 7168
    buffer_load_dwordx4 v3, s[8:11], s40 offen lds
    s_add_u32 m0, s42, 3072
    s_nop 0
    buffer_load_dwordx4 v3, s[8:11], s36 offen lds
    s_add_u32 s40, s40, 14336
    s_waitcnt vmcnt(28)
    ds_read_b64_tr_b16 v[24:25], v4 offset:6144
    ds_read_b64_tr_b16 v[26:27], v5 offset:6144
    ds_read_b64_tr_b16 v[28:29], v6 offset:6144
    ds_read_b64_tr_b16 v[30:31], v7 offset:6144
    s_waitcnt lgkmcnt(4)
    v_mfma_f32_32x32x16_bf16 v[128:143], v[16:19], v[48:51], v[128:143]
    v_mfma_f32_32x32x16_bf16 v[144:159], v[20:23], v[48:51], v[144:159]
    v_mfma_f32_32x32x16_bf16 v[160:175], v[16:19], v[52:55], v[160:175]
    v_mfma_f32_32x32x16_bf16 v[176:191], v[20:23], v[52:55], v[176:191]
    buffer_load_dwordx4 v[48:51], v2, s[4:7], s41 offen sc0 sc1
    s_add_u32 s36, s41, 114688
    buffer_load_dwordx4 v[52:55], v2, s[4:7], s36 offen sc0 sc1
    s_add_u32 s41, s41, 1024
    s_add_u32 m0, s42, 4096
    s_add_u32 s36, s40, 7168
    buffer_load_dwordx4 v3, s[8:11], s40 offen lds
    s_add_u32 m0, s42, 5120
    s_nop 0
    buffer_load_dwordx4 v3, s[8:11], s36 offen lds
    s_add_u32 s40, s40, 14336
    s_waitcnt vmcnt(30)
    ds_read_b64_tr_b16 v[16:17], v4 offset:8192
    ds_read_b64_tr_b16 v[18:19], v5 offset:8192
    ds_read_b64_tr_b16 v[20:21], v6 offset:8192
    ds_read_b64_tr_b16 v[22:23], v7 offset:8192
    s_waitcnt lgkmcnt(4)
    v_mfma_f32_32x32x16_bf16 v[128:143], v[24:27], v[56:59], v[128:143]
    v_mfma_f32_32x32x16_bf16 v[144:159], v[28:31], v[56:59], v[144:159]
    v_mfma_f32_32x32x16_bf16 v[160:175], v[24:27], v[60:63], v[160:175]
    v_mfma_f32_32x32x16_bf16 v[176:191], v[28:31], v[60:63], v[176:191]
    buffer_load_dwordx4 v[56:59], v2, s[4:7], s41 offen sc0 sc1
    s_add_u32 s36, s41, 114688
    buffer_load_dwordx4 v[60:63], v2, s[4:7], s36 offen sc0 sc1
    s_add_u32 s41, s41, 1024
    s_add_u32 m0, s42, 6144
    s_add_u32 s36, s40, 7168
    buffer_load_dwordx4 v3, s[8:11], s40 offen lds
    s_add_u32 m0, s42, 7168
    s_nop 0
    buffer_load_dwordx4 v3, s[8:11], s36 offen lds
    s_add_u32 s40, s40, 14336
    s_waitcnt vmcnt(16)
    ds_read_b64_tr_b16 v[24:25], v4 offset:10240
    ds_read_b64_tr_b16 v[26:27], v5 offset:10240
    ds_read_b64_tr_b16 v[28:29], v6 offset:10240
    ds_read_b64_tr_b16 v[30:31], v7 offset:10240
    s_waitcnt lgkmcnt(4)
    v_mfma_f32_32x32x16_bf16 v[128:143], v[16:19], v[64:67], v[128:143]
    v_mfma_f32_32x32x16_bf16 v[144:159], v[20:23], v[64:67], v[144:159]
    v_mfma_f32_32x32x16_bf16 v[160:175], v[16:19], v[68:71], v[160:175]
    v_mfma_f32_32x32x16_bf16 v[176:191], v[20:23], v[68:71], v[176:191]
    buffer_load_dwordx4 v[64:67], v2, s[4:7], s41 offen sc0 sc1
    s_add_u32 s36, s41, 114688
    buffer_load_dwordx4 v[68:71], v2, s[4:7], s36 offen sc0 sc1
    s_add_u32 s41, s41, 1024
    s_add_u32 m0, s42, 8192
    s_add_u32 s36, s40, 7168
    buffer_load_dwordx4 v3, s[8:11], s40 offen lds
    s_add_u32 m0, s42, 9216
    s_nop 0
    buffer_load_dwordx4 v3, s[8:11], s36 offen lds
    s_add_u32 s40, s40, 14336
    s_waitcnt vmcnt(16)
    ds_read_b64_tr_b16 v[16:17], v4 offset:0
    ds_read_b64_tr_b16 v[18:19], v5 offset:0
    ds_read_b64_tr_b16 v[20:21], v6 offset:0
    ds_read_b64_tr_b16 v[22:23], v7 offset:0
    s_waitcnt lgkmcnt(4)
    v_mfma_f32_32x32x16_bf16 v[128:143], v[24:27], v[72:75], v[128:143]
    v_mfma_f32_32x32x16_bf16 v[144:159], v[28:31], v[72:75], v[144:159]
    v_mfma_f32_32x32x16_bf16 v[160:175], v[24:27], v[76:79], v[160:175]
    v_mfma_f32_32x32x16_bf16 v[176:191], v[28:31], v[76:79], v[176:191]
    buffer_load_dwordx4 v[72:75], v2, s[4:7], s41 offen sc0 sc1
    s_add_u32 s36, s41, 114688
    buffer_load_dwordx4 v[76:79], v2, s[4:7], s36 offen sc0 sc1
    s_add_u32 s41, s41, 1024
    s_add_u32 m0, s42, 10240
    s_add_u32 s36, s40, 7168
    buffer_load_dwordx4 v3, s[8:11], s40 offen lds
    s_add_u32 m0, s42, 11264
    s_nop 0
    buffer_load_dwordx4 v3, s[8:11], s36 offen lds
    s_add_u32 s40, s40, 14336
    s_waitcnt vmcnt(16)
    ds_read_b64_tr_b16 v[24:25], v4 offset:2048
    ds_read_b64_tr_b16 v[26:27], v5 offset:2048
    ds_read_b64_tr_b16 v[28:29], v6 offset:2048
    ds_read_b64_tr_b16 v[30:31], v7 offset:2048
    s_waitcnt lgkmcnt(4)
    v_mfma_f32_32x32x16_bf16 v[128:143], v[16:19], v[80:83], v[128:143]
    v_mfma_f32_32x32x16_bf16 v[144:159], v[20:23], v[80:83], v[144:159]
    v_mfma_f32_32x32x16_bf16 v[160:175], v[16:19], v[84:87], v[160:175]
    v_mfma_f32_32x32x16_bf16 v[176:191], v[20:23], v[84:87], v[176:191]
    buffer_load_dwordx4 v[80:83], v2, s[4:7], s41 offen sc0 sc1
    s_add_u32 s36, s41, 114688
    buffer_load_dwordx4 v[84:87], v2, s[4:7], s36 offen sc0 sc1
    s_add_u32 s41, s41, 1024
    s_add_u32 m0, s42, 0
    s_add_u32 s36, s40, 7168
    buffer_load_dwordx4 v3, s[8:11], s40 offen lds
    s_add_u32 m0, s42, 1024
    s_nop 0
    buffer_load_dwordx4 v3, s[8:11], s36 offen lds
    s_add_u32 s40, s40, 14336
    s_waitcnt vmcnt(16)
    ds_read_b64_tr_b16 v[16:17], v4 offset:4096
    ds_read_b64_tr_b16 v[18:19], v5 offset:4096
    ds_read_b64_tr_b16 v[20:21], v6 offset:4096
    ds_read_b64_tr_b16 v[22:23], v7 offset:4096
    s_waitcnt lgkmcnt(4)
    v_mfma_f32_32x32x16_bf16 v[128:143], v[24:27], v[88:91], v[128:143]
    v_mfma_f32_32x32x16_bf16 v[144:159], v[28:31], v[88:91], v[144:159]
    v_mfma_f32_32x32x16_bf16 v[160:175], v[24:27], v[92:95], v[160:175]
    v_mfma_f32_32x32x16_bf16 v[176:191], v[28:31], v[92:95], v[176:191]
    buffer_load_dwordx4 v[88:91], v2, s[4:7], s41 offen sc0 sc1
    s_add_u32 s36, s41, 114688
    buffer_load_dwordx4 v[92:95], v2, s[4:7], s36 offen sc0 sc1
    s_add_u32 s41, s41, 1024
    s_add_u32 m0, s42, 2048
    s_add_u32 s36, s40, 7168
    buffer_load_dwordx4 v3, s[8:11], s40 offen lds
    s_add_u32 m0, s42, 3072
    s_nop 0
    buffer_load_dwordx4 v3, s[8:11], s36 offen lds
    s_add_u32 s40, s40, 14336
    s_waitcnt vmcnt(16)
    ds_read_b64_tr_b16 v[24:25], v4 offset:6144
    ds_read_b64_tr_b16 v[26:27], v5 offset:6144
    ds_read_b64_tr_b16 v[28:29], v6 offset:6144
    ds_read_b64_tr_b16 v[30:31], v7 offset:6144
    s_waitcnt lgkmcnt(4)
    v_mfma_f32_32x32x16_bf16 v[128:143], v[16:19], v[96:99], v[128:143]
    v_mfma_f32_32x32x16_bf16 v[144:159], v[20:23], v[96:99], v[144:159]
    v_mfma_f32_32x32x16_bf16 v[160:175], v[16:19], v[100:103], v[160:175]
    v_mfma_f32_32x32x16_bf16 v[176:191], v[20:23], v[100:103], v[176:191]
    buffer_load_dwordx4 v[96:99], v2, s[4:7], s41 offen sc0 sc1
    s_add_u32 s36, s41, 114688
    buffer_load_dwordx4 v[100:103], v2, s[4:7], s36 offen sc0 sc1
    s_add_u32 s41, s41, 1024
    s_add_u32 m0, s42, 4096
    s_add_u32 s36, s40, 7168
    buffer_load_dwordx4 v3, s[8:11], s40 offen lds
    s_add_u32 m0, s42, 5120
    s_nop 0
    buffer_load_dwordx4 v3, s[8:11], s36 offen lds
    s_add_u32 s40, s40, 14336
    s_waitcnt vmcnt(16)
    ds_read_b64_tr_b16 v[16:17], v4 offset:8192
    ds_read_b64_tr_b16 v[18:19], v5 offset:8192
    ds_read_b64_tr_b16 v[20:21], v6 offset:8192
    ds_read_b64_tr_b16 v[22:23], v7 offset:8192
    s_waitcnt lgkmcnt(4)
    v_mfma_f32_32x32x16_bf16 v[128:143], v[24:27], v[104:107], v[128:143]
    v_mfma_f32_32x32x16_bf16 v[144:159], v[28:31], v[104:107], v[144:159]
    v_mfma_f32_32x32x16_bf16 v[160:175], v[24:27], v[108:111], v[160:175]
    v_mfma_f32_32x32x16_bf16 v[176:191], v[28:31], v[108:111], v[176:191]
    buffer_load_dwordx4 v[104:107], v2, s[4:7], s41 offen sc0 sc1
    s_add_u32 s36, s41, 114688
    buffer_load_dwordx4 v[108:111], v2, s[4:7], s36 offen sc0 sc1
    s_add_u32 s41, s41, 1024
    s_add_u32 m0, s42, 6144
    s_add_u32 s36, s40, 7168
    buffer_load_dwordx4 v3, s[8:11], s40 offen lds
    s_add_u32 m0, s42, 7168
    s_nop 0
    buffer_load_dwordx4 v3, s[8:11], s36 offen lds
    s_add_u32 s40, s40, 14336
    s_waitcnt vmcnt(16)
    ds_read_b64_tr_b16 v[24:25], v4 offset:10240
    ds_read_b64_tr_b16 v[26:27], v5 offset:10240
    ds_read_b64_tr_b16 v[28:29], v6 offset:10240
    ds_read_b64_tr_b16 v[30:31], v7 offset:10240
    s_waitcnt lgkmcnt(4)
    v_mfma_f32_32x32x16_bf16 v[128:143], v[16:19], v[112:115], v[128:143]
    v_mfma_f32_32x32x16_bf16 v[144:159], v[20:23], v[112:115], v[144:159]
    v_mfma_f32_32x32x16_bf16 v[160:175], v[16:19], v[116:119], v[160:175]
    v_mfma_f32_32x32x16_bf16 v[176:191], v[20:23], v[116:119], v[176:191]
    buffer_load_dwordx4 v[112:115], v2, s[4:7], s41 offen sc0 sc1
    s_add_u32 s36, s41, 114688
    buffer_load_dwordx4 v[116:119], v2, s[4:7], s36 offen sc0 sc1
    s_add_u32 s41, s41, 1024
    s_add_u32 m0, s42, 8192
    s_add_u32 s36, s40, 7168
    buffer_load_dwordx4 v3, s[8:11], s40 offen lds
    s_add_u32 m0, s42, 9216
    s_nop 0
    buffer_load_dwordx4 v3, s[8:11], s36 offen lds
    s_add_u32 s40, s40, 14336
    s_waitcnt vmcnt(16)
    ds_read_b64_tr_b16 v[16:17], v4 offset:0
    ds_read_b64_tr_b16 v[18:19], v5 offset:0
    ds_read_b64_tr_b16 v[20:21], v6 offset:0
    ds_read_b64_tr_b16 v[22:23], v7 offset:0
    s_waitcnt lgkmcnt(4)
    v_mfma_f32_32x32x16_bf16 v[128:143], v[24:27], v[120:123], v[128:143]
    v_mfma_f32_32x32x16_bf16 v[144:159], v[28:31], v[120:123], v[144:159]
    v_mfma_f32_32x32x16_bf16 v[160:175], v[24:27], v[124:127], v[160:175]
    v_mfma_f32_32x32x16_bf16 v[176:191], v[28:31], v[124:127], v[176:191]
    buffer_load_dwordx4 v[120:123], v2, s[4:7], s41 offen sc0 sc1
    s_add_u32 s36, s41, 114688
    buffer_load_dwordx4 v[124:127], v2, s[4:7], s36 offen sc0 sc1
    s_add_u32 s41, s41, 1024
    s_add_u32 m0, s42, 10240
    s_add_u32 s36, s40, 7168
    buffer_load_dwordx4 v3, s[8:11], s40 offen lds
    s_add_u32 m0, s42, 11264
    s_nop 0
    buffer_load_dwordx4 v3, s[8:11], s36 offen lds
    s_add_u32 s40, s40, 14336
    s_waitcnt vmcnt(16)
    ds_read_b64_tr_b16 v[24:25], v4 offset:2048
    ds_read_b64_tr_b16 v[26:27], v5 offset:2048
    ds_read_b64_tr_b16 v[28:29], v6 offset:2048
    ds_read_b64_tr_b16 v[30:31], v7 offset:2048
    s_waitcnt lgkmcnt(4)
    v_mfma_f32_32x32x16_bf16 v[128:143], v[16:19], v[32:35], v[128:143]
    v_mfma_f32_32x32x16_bf16 v[144:159], v[20:23], v[32:35], v[144:159]
    v_mfma_f32_32x32x16_bf16 v[160:175], v[16:19], v[36:39], v[160:175]
    v_mfma_f32_32x32x16_bf16 v[176:191], v[20:23], v[36:39], v[176:191]
    buffer_load_dwordx4 v[32:35], v2, s[4:7], s41 offen sc0 sc1
    s_add_u32 s36, s41, 114688
    buffer_load_dwordx4 v[36:39], v2, s[4:7], s36 offen sc0 sc1
    s_add_u32 s41, s41, 1024
    s_add_u32 m0, s42, 0
    s_add_u32 s36, s40, 7168
    buffer_load_dwordx4 v3, s[8:11], s40 offen lds
    s_add_u32 m0, s42, 1024
    s_nop 0
    buffer_load_dwordx4 v3, s[8:11], s36 offen lds
    s_add_u32 s40, s40, 14336
    s_waitcnt vmcnt(16)
    ds_read_b64_tr_b16 v[16:17], v4 offset:4096
    ds_read_b64_tr_b16 v[18:19], v5 offset:4096
    ds_read_b64_tr_b16 v[20:21], v6 offset:4096
    ds_read_b64_tr_b16 v[22:23], v7 offset:4096
    s_waitcnt lgkmcnt(4)
    v_mfma_f32_32x32x16_bf16 v[128:143], v[24:27], v[40:43], v[128:143]
    v_mfma_f32_32x32x16_bf16 v[144:159], v[28:31], v[40:43], v[144:159]
    v_mfma_f32_32x32x16_bf16 v[160:175], v[24:27], v[44:47], v[160:175]
    v_mfma_f32_32x32x16_bf16 v[176:191], v[28:31], v[44:47], v[176:191]
    buffer_load_dwordx4 v[40:43], v2, s[4:7], s41 offen sc0 sc1
    s_add_u32 s36, s41, 114688
    buffer_load_dwordx4 v[44:47], v2, s[4:7], s36 offen sc0 sc1
    s_add_u32 s41, s41, 1024
    s_add_u32 m0, s42, 2048
    s_add_u32 s36, s40, 7168
    buffer_load_dwordx4 v3, s[8:11], s40 offen lds
    s_add_u32 m0, s42, 3072
    s_nop 0
    buffer_load_dwordx4 v3, s[8:11], s36 offen lds
    s_add_u32 s40, s40, 14336
    s_waitcnt vmcnt(16)
    ds_read_b64_tr_b16 v[24:25], v4 offset:6144
    ds_read_b64_tr_b16 v[26:27], v5 offset:6144
    ds_read_b64_tr_b16 v[28:29], v6 offset:6144
    ds_read_b64_tr_b16 v[30:31], v7 offset:6144
    s_waitcnt lgkmcnt(4)
    v_mfma_f32_32x32x16_bf16 v[128:143], v[16:19], v[48:51], v[128:143]
    v_mfma_f32_32x32x16_bf16 v[144:159], v[20:23], v[48:51], v[144:159]
    v_mfma_f32_32x32x16_bf16 v[160:175], v[16:19], v[52:55], v[160:175]
    v_mfma_f32_32x32x16_bf16 v[176:191], v[20:23], v[52:55], v[176:191]
    buffer_load_dwordx4 v[48:51], v2, s[4:7], s41 offen sc0 sc1
    s_add_u32 s36, s41, 114688
    buffer_load_dwordx4 v[52:55], v2, s[4:7], s36 offen sc0 sc1
    s_add_u32 s41, s41, 1024
    s_add_u32 m0, s42, 4096
    s_add_u32 s36, s40, 7168
    buffer_load_dwordx4 v3, s[8:11], s40 offen lds
    s_add_u32 m0, s42, 5120
    s_nop 0
    buffer_load_dwordx4 v3, s[8:11], s36 offen lds
    s_add_u32 s40, s40, 14336
    s_waitcnt vmcnt(16)
    ds_read_b64_tr_b16 v[16:17], v4 offset:8192
    ds_read_b64_tr_b16 v[18:19], v5 offset:8192
    ds_read_b64_tr_b16 v[20:21], v6 offset:8192
    ds_read_b64_tr_b16 v[22:23], v7 offset:8192
    s_waitcnt lgkmcnt(4)
    v_mfma_f32_32x32x16_bf16 v[128:143], v[24:27], v[56:59], v[128:143]
    v_mfma_f32_32x32x16_bf16 v[144:159], v[28:31], v[56:59], v[144:159]
    v_mfma_f32_32x32x16_bf16 v[160:175], v[24:27], v[60:63], v[160:175]
    v_mfma_f32_32x32x16_bf16 v[176:191], v[28:31], v[60:63], v[176:191]
    buffer_load_dwordx4 v[56:59], v2, s[4:7], s41 offen sc0 sc1
    s_add_u32 s36, s41, 114688
    buffer_load_dwordx4 v[60:63], v2, s[4:7], s36 offen sc0 sc1
    s_add_u32 s41, s41, 1024
    s_add_u32 m0, s42, 6144
    s_add_u32 s36, s40, 7168
    buffer_load_dwordx4 v3, s[8:11], s40 offen lds
    s_add_u32 m0, s42, 7168
    s_nop 0
    buffer_load_dwordx4 v3, s[8:11], s36 offen lds
    s_add_u32 s40, s40, 14336
    s_waitcnt vmcnt(16)
    ds_read_b64_tr_b16 v[24:25], v4 offset:10240
    ds_read_b64_tr_b16 v[26:27], v5 offset:10240
    ds_read_b64_tr_b16 v[28:29], v6 offset:10240
    ds_read_b64_tr_b16 v[30:31], v7 offset:10240
    s_waitcnt lgkmcnt(4)
    v_mfma_f32_32x32x16_bf16 v[128:143], v[16:19], v[64:67], v[128:143]
    v_mfma_f32_32x32x16_bf16 v[144:159], v[20:23], v[64:67], v[144:159]
    v_mfma_f32_32x32x16_bf16 v[160:175], v[16:19], v[68:71], v[160:175]
    v_mfma_f32_32x32x16_bf16 v[176:191], v[20:23], v[68:71], v[176:191]
    s_add_u32 m0, s42, 8192
    s_add_u32 s36, s40, 7168
    buffer_load_dwordx4 v3, s[8:11], s40 offen lds
    s_add_u32 m0, s42, 9216
    s_nop 0
    buffer_load_dwordx4 v3, s[8:11], s36 offen lds
    s_add_u32 s40, s40, 14336
    s_waitcnt vmcnt(14)
    ds_read_b64_tr_b16 v[16:17], v4 offset:0
    ds_read_b64_tr_b16 v[18:19], v5 offset:0
    ds_read_b64_tr_b16 v[20:21], v6 offset:0
    ds_read_b64_tr_b16 v[22:23], v7 offset:0
    s_waitcnt lgkmcnt(4)
    v_mfma_f32_32x32x16_bf16 v[128:143], v[24:27], v[72:75], v[128:143]
    v_mfma_f32_32x32x16_bf16 v[144:159], v[28:31], v[72:75], v[144:159]
    v_mfma_f32_32x32x16_bf16 v[160:175], v[24:27], v[76:79], v[160:175]
    v_mfma_f32_32x32x16_bf16 v[176:191], v[28:31], v[76:79], v[176:191]
    s_add_u32 m0, s42, 10240
    s_add_u32 s36, s40, 7168
    buffer_load_dwordx4 v3, s[8:11], s40 offen lds
    s_add_u32 m0, s42, 11264
    s_nop 0
    buffer_load_dwordx4 v3, s[8:11], s36 offen lds
    s_add_u32 s40, s40, 14336
    s_waitcnt vmcnt(12)
    ds_read_b64_tr_b16 v[24:25], v4 offset:2048
    ds_read_b64_tr_b16 v[26:27], v5 offset:2048
    ds_read_b64_tr_b16 v[28:29], v6 offset:2048
    ds_read_b64_tr_b16 v[30:31], v7 offset:2048
    s_waitcnt lgkmcnt(4)
    v_mfma_f32_32x32x16_bf16 v[128:143], v[16:19], v[80:83], v[128:143]
    v_mfma_f32_32x32x16_bf16 v[144:159], v[20:23], v[80:83], v[144:159]
    v_mfma_f32_32x32x16_bf16 v[160:175], v[16:19], v[84:87], v[160:175]
    v_mfma_f32_32x32x16_bf16 v[176:191], v[20:23], v[84:87], v[176:191]
    s_add_u32 m0, s42, 0
    s_add_u32 s36, s40, 7168
    buffer_load_dwordx4 v3, s[8:11], s40 offen lds
    s_add_u32 m0, s42, 1024
    s_nop 0
    buffer_load_dwordx4 v3, s[8:11], s36 offen lds
    s_add_u32 s40, s40, 14336
    s_waitcnt vmcnt(10)
    ds_read_b64_tr_b16 v[16:17], v4 offset:4096
    ds_read_b64_tr_b16 v[18:19], v5 offset:4096
    ds_read_b64_tr_b16 v[20:21], v6 offset:4096
    ds_read_b64_tr_b16 v[22:23], v7 offset:4096
    s_waitcnt lgkmcnt(4)
    v_mfma_f32_32x32x16_bf16 v[128:143], v[24:27], v[88:91], v[128:143]
    v_mfma_f32_32x32x16_bf16 v[144:159], v[28:31], v[88:91], v[144:159]
    v_mfma_f32_32x32x16_bf16 v[160:175], v[24:27], v[92:95], v[160:175]
    v_mfma_f32_32x32x16_bf16 v[176:191], v[28:31], v[92:95], v[176:191]
    s_add_u32 m0, s42, 2048
    s_add_u32 s36, s40, 7168
    buffer_load_dwordx4 v3, s[8:11], s40 offen lds
    s_add_u32 m0, s42, 3072
    s_nop 0
    buffer_load_dwordx4 v3, s[8:11], s36 offen lds
    s_add_u32 s40, s40, 14336
    s_waitcnt vmcnt(8)
    ds_read_b64_tr_b16 v[24:25], v4 offset:6144
    ds_read_b64_tr_b16 v[26:27], v5 offset:6144
    ds_read_b64_tr_b16 v[28:29], v6 offset:6144
    ds_read_b64_tr_b16 v[30:31], v7 offset:6144
    s_waitcnt lgkmcnt(4)
    v_mfma_f32_32x32x16_bf16 v[128:143], v[16:19], v[96:99], v[128:143]
    v_mfma_f32_32x32x16_bf16 v[144:159], v[20:23], v[96:99], v[144:159]
    v_mfma_f32_32x32x16_bf16 v[160:175], v[16:19], v[100:103], v[160:175]
    v_mfma_f32_32x32x16_bf16 v[176:191], v[20:23], v[100:103], v[176:191]
    s_add_u32 m0, s42, 4096
    s_add_u32 s36, s40, 7168
    buffer_load_dwordx4 v3, s[8:11], s40 offen lds
    s_add_u32 m0, s42, 5120
    s_nop 0
    buffer_load_dwordx4 v3, s[8:11], s36 offen lds
    s_add_u32 s40, s40, 14336
    s_waitcnt vmcnt(8)
    ds_read_b64_tr_b16 v[16:17], v4 offset:8192
    ds_read_b64_tr_b16 v[18:19], v5 offset:8192
    ds_read_b64_tr_b16 v[20:21], v6 offset:8192
    ds_read_b64_tr_b16 v[22:23], v7 offset:8192
    s_waitcnt lgkmcnt(4)
    v_mfma_f32_32x32x16_bf16 v[128:143], v[24:27], v[104:107], v[128:143]
    v_mfma_f32_32x32x16_bf16 v[144:159], v[28:31], v[104:107], v[144:159]
    v_mfma_f32_32x32x16_bf16 v[160:175], v[24:27], v[108:111], v[160:175]
    v_mfma_f32_32x32x16_bf16 v[176:191], v[28:31], v[108:111], v[176:191]
    s_add_u32 m0, s42, 6144
    s_add_u32 s36, s40, 7168
    buffer_load_dwordx4 v3, s[8:11], s40 offen lds
    s_add_u32 m0, s42, 7168
    s_nop 0
    buffer_load_dwordx4 v3, s[8:11], s36 offen lds
    s_add_u32 s40, s40, 14336
    s_waitcnt vmcnt(8)
    ds_read_b64_tr_b16 v[24:25], v4 offset:10240
    ds_read_b64_tr_b16 v[26:27], v5 offset:10240
    ds_read_b64_tr_b16 v[28:29], v6 offset:10240
    ds_read_b64_tr_b16 v[30:31], v7 offset:10240
    s_waitcnt lgkmcnt(4)
    v_mfma_f32_32x32x16_bf16 v[128:143], v[16:19], v[112:115], v[128:143]
    v_mfma_f32_32x32x16_bf16 v[144:159], v[20:23], v[112:115], v[144:159]
    v_mfma_f32_32x32x16_bf16 v[160:175], v[16:19], v[116:119], v[160:175]
    v_mfma_f32_32x32x16_bf16 v[176:191], v[20:23], v[116:119], v[176:191]
    s_waitcnt vmcnt(6)
    ds_read_b64_tr_b16 v[16:17], v4 offset:0
    ds_read_b64_tr_b16 v[18:19], v5 offset:0
    ds_read_b64_tr_b16 v[20:21], v6 offset:0
    ds_read_b64_tr_b16 v[22:23], v7 offset:0
    s_waitcnt lgkmcnt(4)
    v_mfma_f32_32x32x16_bf16 v[128:143], v[24:27], v[120:123], v[128:143]
    v_mfma_f32_32x32x16_bf16 v[144:159], v[28:31], v[120:123], v[144:159]
    v_mfma_f32_32x32x16_bf16 v[160:175], v[24:27], v[124:127], v[160:175]
    v_mfma_f32_32x32x16_bf16 v[176:191], v[28:31], v[124:127], v[176:191]
    s_waitcnt vmcnt(4)
    ds_read_b64_tr_b16 v[24:25], v4 offset:2048
    ds_read_b64_tr_b16 v[26:27], v5 offset:2048
    ds_read_b64_tr_b16 v[28:29], v6 offset:2048
    ds_read_b64_tr_b16 v[30:31], v7 offset:2048
    s_waitcnt lgkmcnt(4)
    v_mfma_f32_32x32x16_bf16 v[128:143], v[16:19], v[32:35], v[128:143]
    v_mfma_f32_32x32x16_bf16 v[144:159], v[20:23], v[32:35], v[144:159]
    v_mfma_f32_32x32x16_bf16 v[160:175], v[16:19], v[36:39], v[160:175]
    v_mfma_f32_32x32x16_bf16 v[176:191], v[20:23], v[36:39], v[176:191]
    s_waitcnt vmcnt(2)
    ds_read_b64_tr_b16 v[16:17], v4 offset:4096
    ds_read_b64_tr_b16 v[18:19], v5 offset:4096
    ds_read_b64_tr_b16 v[20:21], v6 offset:4096
    ds_read_b64_tr_b16 v[22:23], v7 offset:4096
    s_waitcnt lgkmcnt(4)
    v_mfma_f32_32x32x16_bf16 v[128:143], v[24:27], v[40:43], v[128:143]
    v_mfma_f32_32x32x16_bf16 v[144:159], v[28:31], v[40:43], v[144:159]
    v_mfma_f32_32x32x16_bf16 v[160:175], v[24:27], v[44:47], v[160:175]
    v_mfma_f32_32x32x16_bf16 v[176:191], v[28:31], v[44:47], v[176:191]
    s_waitcnt vmcnt(0)
    ds_read_b64_tr_b16 v[24:25], v4 offset:6144
    ds_read_b64_tr_b16 v[26:27], v5 offset:6144
    ds_read_b64_tr_b16 v[28:29], v6 offset:6144
    ds_read_b64_tr_b16 v[30:31], v7 offset:6144
    s_waitcnt lgkmcnt(4)
    v_mfma_f32_32x32x16_bf16 v[128:143], v[16:19], v[48:51], v[128:143]
    v_mfma_f32_32x32x16_bf16 v[144:159], v[20:23], v[48:51], v[144:159]
    v_mfma_f32_32x32x16_bf16 v[160:175], v[16:19], v[52:55], v[160:175]
    v_mfma_f32_32x32x16_bf16 v[176:191], v[20:23], v[52:55], v[176:191]
    s_waitcnt vmcnt(14)
    s_waitcnt lgkmcnt(0)
    v_mfma_f32_32x32x16_bf16 v[128:143], v[24:27], v[56:59], v[128:143]
    v_mfma_f32_32x32x16_bf16 v[144:159], v[28:31], v[56:59], v[144:159]
    v_mfma_f32_32x32x16_bf16 v[160:175], v[24:27], v[60:63], v[160:175]
    v_mfma_f32_32x32x16_bf16 v[176:191], v[28:31], v[60:63], v[176:191]
    v_add_u32 v8, s42, v2
    s_nop 7
    ds_write_b128 v8, v[128:131] offset:0
    ds_write_b128 v8, v[132:135] offset:1024
    ds_write_b128 v8, v[136:139] offset:2048
    ds_write_b128 v8, v[140:143] offset:3072
    ds_write_b128 v8, v[144:147] offset:4096
    ds_write_b128 v8, v[148:151] offset:5120
    ds_write_b128 v8, v[152:155] offset:6144
    ds_write_b128 v8, v[156:159] offset:7168
    ds_write_b128 v8, v[160:163] offset:8192
    ds_write_b128 v8, v[164:167] offset:9216
    ds_write_b128 v8, v[168:171] offset:10240
    ds_write_b128 v8, v[172:175] offset:11264
    ds_write_b128 v8, v[176:179] offset:12288
    ds_write_b128 v8, v[180:183] offset:13312
    ds_write_b128 v8, v[184:187] offset:14336
    ds_write_b128 v8, v[188:191] offset:15360
    s_branch K23_FIN
K23_ATT:
    s_and_b32 s33, s2, 15
    s_lshr_b32 s34, s2, 4
    s_lshl_b32 s35, s34, 2
    s_add_u32 s35, s35, s3
    s_mov_b32 s40, 0
    s_mov_b32 s41, -1
    v_bfe_u32 v6, v1, 2, 2
    v_and_b32 v7, 3, v1
    v_bfe_u32 v8, v1, 4, 1
    v_lshrrev_b32 v9, 5, v1
    v_and_b32 v10, 1, v7
    v_lshlrev_b32 v10, 10, v10
    v_lshrrev_b32 v11, 1, v7
    v_lshl_add_u32 v10, v11, 9, v10
    v_lshrrev_b32 v11, 2, v1
    v_lshl_add_u32 v3, v11, 4, v10
    v_and_b32 v10, 1, v7
    v_lshlrev_b32 v10, 1, v10
    v_lshl_add_u32 v10, v8, 2, v10
    v_lshrrev_b32 v11, 1, v7
    v_add_u32 v10, v10, v11
    v_lshlrev_b32 v10, 3, v10
    v_lshl_add_u32 v11, v9, 2, v6
    v_lshl_add_u32 v10, v11, 6, v10
    s_lshl_b32 s36, s3, 12
    s_add_u32 s37, s36, 2048
    v_add_u32 v4, s37, v10
    s_add_u32 s36, s36, 0
    v_add_u32 v12, s36, v2
    v_and_b32 v10, 31, v1
    v_lshlrev_b32 v11, 2, v9
    v_sub_u32 v5, v10, v11
    s_waitcnt lgkmcnt(0)
    s_mov_b32 s4, s10
    s_mov_b32 s5, s11
    s_mov_b32 s6, 268435456
    s_mov_b32 s7, 0x00020000
    v_mov_b32 v6, 131072
    s_cmp_lg_u32 s3, 0
    s_cbranch_scc1 K23_QW
    v_min_u32 v7, 2, v1
    v_sub_u32 v7, s34, v7
    v_max_i32 v7, 0, v7
    v_lshlrev_b32 v7, 7, v7
    s_mov_b32 s36, 0xF02800
K23_QP:
    buffer_load_dword v8, v7, s[4:7], s36 offen sc0 sc1
    s_waitcnt vmcnt(0)
    v_cmp_gt_u32 vcc, 5, v8
    s_nop 1
    s_cmp_eq_u64 vcc, 0
    s_cbranch_scc1 K23_QOK
    s_sleep 4
    s_branch K23_QP
K23_QOK:
    v_mov_b32 v7, 1
    ds_write_b32 v6, v7 offset:8
    s_branch K23_QGO
K23_QW:
    ds_read_b32 v7, v6 offset:8
    s_waitcnt lgkmcnt(0)
    v_readfirstlane_b32 s36, v7
    s_nop 0
    s_cmp_lg_u32 s36, 0
    s_cbranch_scc1 K23_QGO
    s_sleep 2
    s_branch K23_QW
K23_QGO:
    s_lshl_b32 s36, s33, 6
    s_add_u32 s36, s36, s35
    s_lshl_b32 s36, s36, 11
    buffer_load_dwordx4 v[16:19], v2, s[4:7], s36 offen sc0 sc1
    buffer_load_dwordx4 v[20:23], v2, s[4:7], s36 offen offset:1024 sc0 sc1
    s_lshl_b32 s36, s34, 2
    s_add_u32 s36, s36, s3
    s_add_i32 s36, s36, -8
    s_max_i32 s36, s36, 0
    s_lshl_b32 s37, s33, 6
    s_add_u32 s36, s36, s37
    s_lshl_b32 s36, s36, 11
    s_add_u32 s37, s36, 2097152
    s_add_u32 s38, s36, 4194304
    s_lshl_b32 s39, s3, 12
    s_add_u32 s39, s39, 0
    s_mov_b32 m0, s39
    s_nop 0
    buffer_load_dwordx4 v2, s[4:7], s37 offen sc0 sc1 lds
    buffer_load_dwordx4 v2, s[4:7], s37 offen offset:1024 sc0 sc1 lds
    s_add_u32 m0, s39, 2048
    s_nop 0
    buffer_load_dwordx4 v3, s[4:7], s38 offen sc0 sc1 lds
    s_add_u32 m0, s39, 3072
    s_add_u32 s38, s38, 256
    buffer_load_dwordx4 v3, s[4:7], s38 offen sc0 sc1 lds
    s_lshl_b32 s36, s34, 2
    s_add_u32 s36, s36, s3
    s_add_i32 s36, s36, -4
    s_max_i32 s36, s36, 0
    s_lshl_b32 s37, s33, 6
    s_add_u32 s36, s36, s37
    s_lshl_b32 s36, s36, 11
    s_add_u32 s37, s36, 2097152
    s_add_u32 s38, s36, 4194304
    s_lshl_b32 s39, s3, 12
    s_add_u32 s39, s39, 16384
    s_mov_b32 m0, s39
    s_nop 0
    buffer_load_dwordx4 v2, s[4:7], s37 offen sc0 sc1 lds
    buffer_load_dwordx4 v2, s[4:7], s37 offen offset:1024 sc0 sc1 lds
    s_add_u32 m0, s39, 2048
    s_nop 0
    buffer_load_dwordx4 v3, s[4:7], s38 offen sc0 sc1 lds
    s_add_u32 m0, s39, 3072
    s_add_u32 s38, s38, 256
    buffer_load_dwordx4 v3, s[4:7], s38 offen sc0 sc1 lds
    s_lshl_b32 s36, s34, 2
    s_add_u32 s36, s36, s3
    s_add_i32 s36, s36, 0
    s_max_i32 s36, s36, 0
    s_lshl_b32 s37, s33, 6
    s_add_u32 s36, s36, s37
    s_lshl_b32 s36, s36, 11
    s_add_u32 s37, s36, 2097152
    s_add_u32 s38, s36, 4194304
    s_lshl_b32 s39, s3, 12
    s_add_u32 s39, s39, 32768
    s_mov_b32 m0, s39
    s_nop 0
    buffer_load_dwordx4 v2, s[4:7], s37 offen sc0 sc1 lds
    buffer_load_dwordx4 v2, s[4:7], s37 offen offset:1024 sc0 sc1 lds
    s_add_u32 m0, s39, 2048
    s_nop 0
    buffer_load_dwordx4 v3, s[4:7], s38 offen sc0 sc1 lds
    s_add_u32 m0, s39, 3072
    s_add_u32 s38, s38, 256
    buffer_load_dwordx4 v3, s[4:7], s38 offen sc0 sc1 lds
    s_waitcnt vmcnt(0)
    v_mov_b32 v6, 131072
    v_mov_b32 v7, 1
    s_mov_b64 exec, 1
    ds_add_u32 v6, v7 offset:0
    s_mov_b64 exec, -1
K23_SPa:
    ds_read_b32 v7, v6 offset:0
    s_waitcnt lgkmcnt(0)
    v_readfirstlane_b32 s36, v7
    s_nop 0
    s_cmp_ge_u32 s36, 4
    s_cbranch_scc1 K23_SGa
    s_sleep 1
    s_branch K23_SPa
K23_SGa:
    ds_read_b128 v[24:27], v12 offset:0
    ds_read_b128 v[28:31], v12 offset:1024
    ds_read_b128 v[32:35], v12 offset:4096
    ds_read_b128 v[36:39], v12 offset:5120
    s_waitcnt lgkmcnt(2)
    v_mfma_f32_32x32x16_bf16 v[96:111], v[24:27], v[16:19], 0
    v_mfma_f32_32x32x16_bf16 v[96:111], v[28:31], v[20:23], v[96:111]
    ds_read_b128 v[24:27], v12 offset:8192
    ds_read_b128 v[28:31], v12 offset:9216
    s_waitcnt lgkmcnt(2)
    v_mfma_f32_32x32x16_bf16 v[112:127], v[32:35], v[16:19], 0
    v_mfma_f32_32x32x16_bf16 v[112:127], v[36:39], v[20:23], v[112:127]
    ds_read_b128 v[32:35], v12 offset:12288
    ds_read_b128 v[36:39], v12 offset:13312
    s_waitcnt lgkmcnt(2)
    v_mfma_f32_32x32x16_bf16 v[128:143], v[24:27], v[16:19], 0
    v_mfma_f32_32x32x16_bf16 v[128:143], v[28:31], v[20:23], v[128:143]
    ds_read_b128 v[24:27], v12 offset:16384
    ds_read_b128 v[28:31], v12 offset:17408
    s_waitcnt lgkmcnt(2)
    v_mfma_f32_32x32x16_bf16 v[144:159], v[32:35], v[16:19], 0
    v_mfma_f32_32x32x16_bf16 v[144:159], v[36:39], v[20:23], v[144:159]
    ds_read_b128 v[32:35], v12 offset:20480
    ds_read_b128 v[36:39], v12 offset:21504
    s_waitcnt lgkmcnt(2)
    v_mfma_f32_32x32x16_bf16 v[160:175], v[24:27], v[16:19], 0
    v_mfma_f32_32x32x16_bf16 v[160:175], v[28:31], v[20:23], v[160:175]
    ds_read_b128 v[24:27], v12 offset:24576
    ds_read_b128 v[28:31], v12 offset:25600
    s_waitcnt lgkmcnt(2)
    v_mfma_f32_32x32x16_bf16 v[176:191], v[32:35], v[16:19], 0
    v_mfma_f32_32x32x16_bf16 v[176:191], v[36:39], v[20:23], v[176:191]
    ds_read_b128 v[32:35], v12 offset:28672
    ds_read_b128 v[36:39], v12 offset:29696
    s_waitcnt lgkmcnt(2)
    v_mfma_f32_32x32x16_bf16 v[192:207], v[24:27], v[16:19], 0
    v_mfma_f32_32x32x16_bf16 v[192:207], v[28:31], v[20:23], v[192:207]
    ds_read_b128 v[24:27], v12 offset:32768
    ds_read_b128 v[28:31], v12 offset:33792
    s_waitcnt lgkmcnt(2)
    v_mfma_f32_32x32x16_bf16 v[208:223], v[32:35], v[16:19], 0
    v_mfma_f32_32x32x16_bf16 v[208:223], v[36:39], v[20:23], v[208:223]
    s_waitcnt lgkmcnt(0)
    v_mfma_f32_32x32x16_bf16 v[224:239], v[24:27], v[16:19], 0
    v_mfma_f32_32x32x16_bf16 v[224:239], v[28:31], v[20:23], v[224:239]
    s_cmp_ge_u32 s35, 8
    s_cbranch_scc1 K2_NOINV
    s_nop 15
    s_add_u32 s36, s35, 0
    s_cmp_ge_u32 s36, 8
    s_cbranch_scc1 K2_NOINV2
    v_mov_b32 v96, 0xf149f2ca
    v_mov_b32 v97, 0xf149f2ca
    v_mov_b32 v98, 0xf149f2ca
    v_mov_b32 v99, 0xf149f2ca
    v_mov_b32 v100, 0xf149f2ca
    v_mov_b32 v101, 0xf149f2ca
    v_mov_b32 v102, 0xf149f2ca
    v_mov_b32 v103, 0xf149f2ca
    v_mov_b32 v104, 0xf149f2ca
    v_mov_b32 v105, 0xf149f2ca
    v_mov_b32 v106, 0xf149f2ca
    v_mov_b32 v107, 0xf149f2ca
    v_mov_b32 v108, 0xf149f2ca
    v_mov_b32 v109, 0xf149f2ca
    v_mov_b32 v110, 0xf149f2ca
    v_mov_b32 v111, 0xf149f2ca
    s_add_u32 s36, s35, 1
    s_cmp_ge_u32 s36, 8
    s_cbranch_scc1 K2_NOINV2
    v_mov_b32 v112, 0xf149f2ca
    v_mov_b32 v113, 0xf149f2ca
    v_mov_b32 v114, 0xf149f2ca
    v_mov_b32 v115, 0xf149f2ca
    v_mov_b32 v116, 0xf149f2ca
    v_mov_b32 v117, 0xf149f2ca
    v_mov_b32 v118, 0xf149f2ca
    v_mov_b32 v119, 0xf149f2ca
    v_mov_b32 v120, 0xf149f2ca
    v_mov_b32 v121, 0xf149f2ca
    v_mov_b32 v122, 0xf149f2ca
    v_mov_b32 v123, 0xf149f2ca
    v_mov_b32 v124, 0xf149f2ca
    v_mov_b32 v125, 0xf149f2ca
    v_mov_b32 v126, 0xf149f2ca
    v_mov_b32 v127, 0xf149f2ca
    s_add_u32 s36, s35, 2
    s_cmp_ge_u32 s36, 8
    s_cbranch_scc1 K2_NOINV2
    v_mov_b32 v128, 0xf149f2ca
    v_mov_b32 v129, 0xf149f2ca
    v_mov_b32 v130, 0xf149f2ca
    v_mov_b32 v131, 0xf149f2ca
    v_mov_b32 v132, 0xf149f2ca
    v_mov_b32 v133, 0xf149f2ca
    v_mov_b32 v134, 0xf149f2ca
    v_mov_b32 v135, 0xf149f2ca
    v_mov_b32 v136, 0xf149f2ca
    v_mov_b32 v137, 0xf149f2ca
    v_mov_b32 v138, 0xf149f2ca
    v_mov_b32 v139, 0xf149f2ca
    v_mov_b32 v140, 0xf149f2ca
    v_mov_b32 v141, 0xf149f2ca
    v_mov_b32 v142, 0xf149f2ca
    v_mov_b32 v143, 0xf149f2ca
    s_add_u32 s36, s35, 3
    s_cmp_ge_u32 s36, 8
    s_cbranch_scc1 K2_NOINV2
    v_mov_b32 v144, 0xf149f2ca
    v_mov_b32 v145, 0xf149f2ca
    v_mov_b32 v146, 0xf149f2ca
    v_mov_b32 v147, 0xf149f2ca
    v_mov_b32 v148, 0xf149f2ca
    v_mov_b32 v149, 0xf149f2ca
    v_mov_b32 v150, 0xf149f2ca
    v_mov_b32 v151, 0xf149f2ca
    v_mov_b32 v152, 0xf149f2ca
    v_mov_b32 v153, 0xf149f2ca
    v_mov_b32 v154, 0xf149f2ca
    v_mov_b32 v155, 0xf149f2ca
    v_mov_b32 v156, 0xf149f2ca
    v_mov_b32 v157, 0xf149f2ca
    v_mov_b32 v158, 0xf149f2ca
    v_mov_b32 v159, 0xf149f2ca
    s_add_u32 s36, s35, 4
    s_cmp_ge_u32 s36, 8
    s_cbranch_scc1 K2_NOINV2
    v_mov_b32 v160, 0xf149f2ca
    v_mov_b32 v161, 0xf149f2ca
    v_mov_b32 v162, 0xf149f2ca
    v_mov_b32 v163, 0xf149f2ca
    v_mov_b32 v164, 0xf149f2ca
    v_mov_b32 v165, 0xf149f2ca
    v_mov_b32 v166, 0xf149f2ca
    v_mov_b32 v167, 0xf149f2ca
    v_mov_b32 v168, 0xf149f2ca
    v_mov_b32 v169, 0xf149f2ca
    v_mov_b32 v170, 0xf149f2ca
    v_mov_b32 v171, 0xf149f2ca
    v_mov_b32 v172, 0xf149f2ca
    v_mov_b32 v173, 0xf149f2ca
    v_mov_b32 v174, 0xf149f2ca
    v_mov_b32 v175, 0xf149f2ca
    s_add_u32 s36, s35, 5
    s_cmp_ge_u32 s36, 8
    s_cbranch_scc1 K2_NOINV2
    v_mov_b32 v176, 0xf149f2ca
    v_mov_b32 v177, 0xf149f2ca
    v_mov_b32 v178, 0xf149f2ca
    v_mov_b32 v179, 0xf149f2ca
    v_mov_b32 v180, 0xf149f2ca
    v_mov_b32 v181, 0xf149f2ca
    v_mov_b32 v182, 0xf149f2ca
    v_mov_b32 v183, 0xf149f2ca
    v_mov_b32 v184, 0xf149f2ca
    v_mov_b32 v185, 0xf149f2ca
    v_mov_b32 v186, 0xf149f2ca
    v_mov_b32 v187, 0xf149f2ca
    v_mov_b32 v188, 0xf149f2ca
    v_mov_b32 v189, 0xf149f2ca
    v_mov_b32 v190, 0xf149f2ca
    v_mov_b32 v191, 0xf149f2ca
    s_add_u32 s36, s35, 6
    s_cmp_ge_u32 s36, 8
    s_cbranch_scc1 K2_NOINV2
    v_mov_b32 v192, 0xf149f2ca
    v_mov_b32 v193, 0xf149f2ca
    v_mov_b32 v194, 0xf149f2ca
    v_mov_b32 v195, 0xf149f2ca
    v_mov_b32 v196, 0xf149f2ca
    v_mov_b32 v197, 0xf149f2ca
    v_mov_b32 v198, 0xf149f2ca
    v_mov_b32 v199, 0xf149f2ca
    v_mov_b32 v200, 0xf149f2ca
    v_mov_b32 v201, 0xf149f2ca
    v_mov_b32 v202, 0xf149f2ca
    v_mov_b32 v203, 0xf149f2ca
    v_mov_b32 v204, 0xf149f2ca
    v_mov_b32 v205, 0xf149f2ca
    v_mov_b32 v206, 0xf149f2ca
    v_mov_b32 v207, 0xf149f2ca
    s_add_u32 s36, s35, 7
    s_cmp_ge_u32 s36, 8
    s_cbranch_scc1 K2_NOINV2
    v_mov_b32 v208, 0xf149f2ca
    v_mov_b32 v209, 0xf149f2ca
    v_mov_b32 v210, 0xf149f2ca
    v_mov_b32 v211, 0xf149f2ca
    v_mov_b32 v212, 0xf149f2ca
    v_mov_b32 v213, 0xf149f2ca
    v_mov_b32 v214, 0xf149f2ca
    v_mov_b32 v215, 0xf149f2ca
    v_mov_b32 v216, 0xf149f2ca
    v_mov_b32 v217, 0xf149f2ca
    v_mov_b32 v218, 0xf149f2ca
    v_mov_b32 v219, 0xf149f2ca
    v_mov_b32 v220, 0xf149f2ca
    v_mov_b32 v221, 0xf149f2ca
    v_mov_b32 v222, 0xf149f2ca
    v_mov_b32 v223, 0xf149f2ca
K2_NOINV2:
K2_NOINV:
    v_mov_b32 v6, 0xf149f2ca
    v_cmp_lt_i32 s[44:45], v5, 0
    v_cmp_lt_i32 s[46:47], v5, 1
    v_cmp_lt_i32 s[48:49], v5, 2
    v_cndmask_b32 v96, v6, v96, s[44:45]
    v_cndmask_b32 v224, v224, v6, s[44:45]
    v_cmp_lt_i32 s[50:51], v5, 3
    v_cndmask_b32 v97, v6, v97, s[46:47]
    v_cndmask_b32 v225, v225, v6, s[46:47]
    v_cmp_lt_i32 s[44:45], v5, 8
    v_cndmask_b32 v98, v6, v98, s[48:49]
    v_cndmask_b32 v226, v226, v6, s[48:49]
    v_cmp_lt_i32 s[46:47], v5, 9
    v_cndmask_b32 v99, v6, v99, s[50:51]
    v_cndmask_b32 v227, v227, v6, s[50:51]
    v_cmp_lt_i32 s[48:49], v5, 10
    v_cndmask_b32 v100, v6, v100, s[44:45]
    v_cndmask_b32 v228, v228, v6, s[44:45]
    v_cmp_lt_i32 s[50:51], v5, 11
    v_cndmask_b32 v101, v6, v101, s[46:47]
    v_cndmask_b32 v229, v229, v6, s[46:47]
    v_cmp_lt_i32 s[44:45], v5, 16
    v_cndmask_b32 v102, v6, v102, s[48:49]
    v_cndmask_b32 v230, v230, v6, s[48:49]
    v_cmp_lt_i32 s[46:47], v5, 17
    v_cndmask_b32 v103, v6, v103, s[50:51]
    v_cndmask_b32 v231, v231, v6, s[50:51]
    v_cmp_lt_i32 s[48:49], v5, 18
    v_cndmask_b32 v104, v6, v104, s[44:45]
    v_cndmask_b32 v232, v232, v6, s[44:45]
    v_cmp_lt_i32 s[50:51], v5, 19
    v_cndmask_b32 v105, v6, v105, s[46:47]
    v_cndmask_b32 v233, v233, v6, s[46:47]
    v_cmp_lt_i32 s[44:45], v5, 24
    v_cndmask_b32 v106, v6, v106, s[48:49]
    v_cndmask_b32 v234, v234, v6, s[48:49]
    v_cmp_lt_i32 s[46:47], v5, 25
    v_cndmask_b32 v107, v6, v107, s[50:51]
    v_cndmask_b32 v235, v235, v6, s[50:51]
    v_cmp_lt_i32 s[48:49], v5, 26
    v_cndmask_b32 v108, v6, v108, s[44:45]
    v_cndmask_b32 v236, v236, v6, s[44:45]
    v_cmp_lt_i32 s[50:51], v5, 27
    v_cndmask_b32 v109, v6, v109, s[46:47]
    v_cndmask_b32 v237, v237, v6, s[46:47]
    v_cndmask_b32 v110, v6, v110, s[48:49]
    v_cndmask_b32 v238, v238, v6, s[48:49]
    v_cndmask_b32 v111, v6, v111, s[50:51]
    v_cndmask_b32 v239, v239, v6, s[50:51]
    v_max_f32 v7, v96, v100
    v_max_f32 v8, v97, v101
    v_max_f32 v9, v98, v102
    v_max_f32 v10, v99, v103
    v_max3_f32 v7, v7, v104, v108
    v_max3_f32 v8, v8, v105, v109
    v_max3_f32 v9, v9, v106, v110
    v_max3_f32 v10, v10, v107, v111
    v_max3_f32 v7, v7, v112, v116
    v_max3_f32 v8, v8, v113, v117
    v_max3_f32 v9, v9, v114, v118
    v_max3_f32 v10, v10, v115, v119
    v_max3_f32 v7, v7, v120, v124
    v_max3_f32 v8, v8, v121, v125
    v_max3_f32 v9, v9, v122, v126
    v_max3_f32 v10, v10, v123, v127
    v_max3_f32 v7, v7, v128, v132
    v_max3_f32 v8, v8, v129, v133
    v_max3_f32 v9, v9, v130, v134
    v_max3_f32 v10, v10, v131, v135
    v_max3_f32 v7, v7, v136, v140
    v_max3_f32 v8, v8, v137, v141
    v_max3_f32 v9, v9, v138, v142
    v_max3_f32 v10, v10, v139, v143
    v_max3_f32 v7, v7, v144, v148
    v_max3_f32 v8, v8, v145, v149
    v_max3_f32 v9, v9, v146, v150
    v_max3_f32 v10, v10, v147, v151
    v_max3_f32 v7, v7, v152, v156
    v_max3_f32 v8, v8, v153, v157
    v_max3_f32 v9, v9, v154, v158
    v_max3_f32 v10, v10, v155, v159
    v_max3_f32 v7, v7, v160, v164
    v_max3_f32 v8, v8, v161, v165
    v_max3_f32 v9, v9, v162, v166
    v_max3_f32 v10, v10, v163, v167
    v_max3_f32 v7, v7, v168, v172
    v_max3_f32 v8, v8, v169, v173
    v_max3_f32 v9, v9, v170, v174
    v_max3_f32 v10, v10, v171, v175
    v_max3_f32 v7, v7, v176, v180
    v_max3_f32 v8, v8, v177, v181
    v_max3_f32 v9, v9, v178, v182
    v_max3_f32 v10, v10, v179, v183
    v_max3_f32 v7, v7, v184, v188
    v_max3_f32 v8, v8, v185, v189
    v_max3_f32 v9, v9, v186, v190
    v_max3_f32 v10, v10, v187, v191
    v_max3_f32 v7, v7, v192, v196
    v_max3_f32 v8, v8, v193, v197
    v_max3_f32 v9, v9, v194, v198
    v_max3_f32 v10, v10, v195, v199
    v_max3_f32 v7, v7, v200, v204
    v_max3_f32 v8, v8, v201, v205
    v_max3_f32 v9, v9, v202, v206
    v_max3_f32 v10, v10, v203, v207
    v_max3_f32 v7, v7, v208, v212
    v_max3_f32 v8, v8, v209, v213
    v_max3_f32 v9, v9, v210, v214
    v_max3_f32 v10, v10, v211, v215
    v_max3_f32 v7, v7, v216, v220
    v_max3_f32 v8, v8, v217, v221
    v_max3_f32 v9, v9, v218, v222
    v_max3_f32 v10, v10, v219, v223
    v_max3_f32 v7, v7, v224, v228
    v_max3_f32 v8, v8, v225, v229
    v_max3_f32 v9, v9, v226, v230
    v_max3_f32 v10, v10, v227, v231
    v_max3_f32 v7, v7, v232, v236
    v_max3_f32 v8, v8, v233, v237
    v_max3_f32 v9, v9, v234, v238
    v_max3_f32 v10, v10, v235, v239
    v_max3_f32 v7, v7, v8, v9
    v_max_f32 v7, v7, v10
    v_mov_b32 v8, v7
    s_nop 1
    v_permlane32_swap_b32 v7, v8
    v_max_f32 v7, v7, v8
    s_mov_b32 s36, 0x3e8b97f6
    v_mul_f32 v11, s36, v7
    v_sub_f32 v11, 0, v11
    ds_read_b64_tr_b16 v[40:41], v4 offset:0
    ds_read_b64_tr_b16 v[42:43], v4 offset:512
    ds_read_b64_tr_b16 v[44:45], v4 offset:1024
    ds_read_b64_tr_b16 v[46:47], v4 offset:1536
    v_fma_f32 v96, v96, s36, v11
    v_fma_f32 v97, v97, s36, v11
    v_fma_f32 v98, v98, s36, v11
    v_fma_f32 v99, v99, s36, v11
    v_fma_f32 v100, v100, s36, v11
    v_fma_f32 v101, v101, s36, v11
    v_fma_f32 v102, v102, s36, v11
    v_fma_f32 v103, v103, s36, v11
    v_exp_f32 v96, v96
    v_exp_f32 v97, v97
    v_exp_f32 v98, v98
    v_exp_f32 v99, v99
    v_exp_f32 v100, v100
    v_exp_f32 v101, v101
    v_exp_f32 v102, v102
    v_exp_f32 v103, v103
    v_cvt_pk_bf16_f32 v72, v96, v97
    v_cvt_pk_bf16_f32 v73, v98, v99
    v_cvt_pk_bf16_f32 v74, v100, v101
    v_cvt_pk_bf16_f32 v75, v102, v103
    ds_read_b64_tr_b16 v[48:49], v4 offset:4096
    ds_read_b64_tr_b16 v[50:51], v4 offset:4608
    s_waitcnt lgkmcnt(4)
    v_mfma_f32_32x32x16_bf16 v[56:71], v[40:43], v[72:75], 0
    v_fma_f32 v104, v104, s36, v11
    v_fma_f32 v105, v105, s36, v11
    v_fma_f32 v106, v106, s36, v11
    v_fma_f32 v107, v107, s36, v11
    v_fma_f32 v108, v108, s36, v11
    v_fma_f32 v109, v109, s36, v11
    v_fma_f32 v110, v110, s36, v11
    v_fma_f32 v111, v111, s36, v11
    v_exp_f32 v104, v104
    v_exp_f32 v105, v105
    v_exp_f32 v106, v106
    v_exp_f32 v107, v107
    v_exp_f32 v108, v108
    v_exp_f32 v109, v109
    v_exp_f32 v110, v110
    v_exp_f32 v111, v111
    v_cvt_pk_bf16_f32 v76, v104, v105
    v_cvt_pk_bf16_f32 v77, v106, v107
    v_cvt_pk_bf16_f32 v78, v108, v109
    v_cvt_pk_bf16_f32 v79, v110, v111
    ds_read_b64_tr_b16 v[52:53], v4 offset:5120
    ds_read_b64_tr_b16 v[54:55], v4 offset:5632
    s_waitcnt lgkmcnt(4)
    v_mfma_f32_32x32x16_bf16 v[56:71], v[44:47], v[76:79], v[56:71]
    v_fma_f32 v112, v112, s36, v11
    v_fma_f32 v113, v113, s36, v11
    v_fma_f32 v114, v114, s36, v11
    v_fma_f32 v115, v115, s36, v11
    v_fma_f32 v116, v116, s36, v11
    v_fma_f32 v117, v117, s36, v11
    v_fma_f32 v118, v118, s36, v11
    v_fma_f32 v119, v119, s36, v11
    v_exp_f32 v112, v112
    v_exp_f32 v113, v113
    v_exp_f32 v114, v114
    v_exp_f32 v115, v115
    v_exp_f32 v116, v116
    v_exp_f32 v117, v117
    v_exp_f32 v118, v118
    v_exp_f32 v119, v119
    v_cvt_pk_bf16_f32 v80, v112, v113
    v_cvt_pk_bf16_f32 v81, v114, v115
    v_cvt_pk_bf16_f32 v82, v116, v117
    v_cvt_pk_bf16_f32 v83, v118, v119
    ds_read_b64_tr_b16 v[40:41], v4 offset:8192
    ds_read_b64_tr_b16 v[42:43], v4 offset:8704
    s_waitcnt lgkmcnt(4)
    v_mfma_f32_32x32x16_bf16 v[56:71], v[48:51], v[80:83], v[56:71]
    v_fma_f32 v120, v120, s36, v11
    v_fma_f32 v121, v121, s36, v11
    v_fma_f32 v122, v122, s36, v11
    v_fma_f32 v123, v123, s36, v11
    v_fma_f32 v124, v124, s36, v11
    v_fma_f32 v125, v125, s36, v11
    v_fma_f32 v126, v126, s36, v11
    v_fma_f32 v127, v127, s36, v11
    v_exp_f32 v120, v120
    v_exp_f32 v121, v121
    v_exp_f32 v122, v122
    v_exp_f32 v123, v123
    v_exp_f32 v124, v124
    v_exp_f32 v125, v125
    v_exp_f32 v126, v126
    v_exp_f32 v127, v127
    v_cvt_pk_bf16_f32 v84, v120, v121
    v_cvt_pk_bf16_f32 v85, v122, v123
    v_cvt_pk_bf16_f32 v86, v124, v125
    v_cvt_pk_bf16_f32 v87, v126, v127
    ds_read_b64_tr_b16 v[44:45], v4 offset:9216
    ds_read_b64_tr_b16 v[46:47], v4 offset:9728
    s_waitcnt lgkmcnt(4)
    v_mfma_f32_32x32x16_bf16 v[56:71], v[52:55], v[84:87], v[56:71]
    v_fma_f32 v128, v128, s36, v11
    v_fma_f32 v129, v129, s36, v11
    v_fma_f32 v130, v130, s36, v11
    v_fma_f32 v131, v131, s36, v11
    v_fma_f32 v132, v132, s36, v11
    v_fma_f32 v133, v133, s36, v11
    v_fma_f32 v134, v134, s36, v11
    v_fma_f32 v135, v135, s36, v11
    v_exp_f32 v128, v128
    v_exp_f32 v129, v129
    v_exp_f32 v130, v130
    v_exp_f32 v131, v131
    v_exp_f32 v132, v132
    v_exp_f32 v133, v133
    v_exp_f32 v134, v134
    v_exp_f32 v135, v135
    v_cvt_pk_bf16_f32 v72, v128, v129
    v_cvt_pk_bf16_f32 v73, v130, v131
    v_cvt_pk_bf16_f32 v74, v132, v133
    v_cvt_pk_bf16_f32 v75, v134, v135
    ds_read_b64_tr_b16 v[48:49], v4 offset:12288
    ds_read_b64_tr_b16 v[50:51], v4 offset:12800
    s_waitcnt lgkmcnt(4)
    v_mfma_f32_32x32x16_bf16 v[56:71], v[40:43], v[72:75], v[56:71]
    v_fma_f32 v136, v136, s36, v11
    v_fma_f32 v137, v137, s36, v11
    v_fma_f32 v138, v138, s36, v11
    v_fma_f32 v139, v139, s36, v11
    v_fma_f32 v140, v140, s36, v11
    v_fma_f32 v141, v141, s36, v11
    v_fma_f32 v142, v142, s36, v11
    v_fma_f32 v143, v143, s36, v11
    v_exp_f32 v136, v136
    v_exp_f32 v137, v137
    v_exp_f32 v138, v138
    v_exp_f32 v139, v139
    v_exp_f32 v140, v140
    v_exp_f32 v141, v141
    v_exp_f32 v142, v142
    v_exp_f32 v143, v143
    v_cvt_pk_bf16_f32 v76, v136, v137
    v_cvt_pk_bf16_f32 v77, v138, v139
    v_cvt_pk_bf16_f32 v78, v140, v141
    v_cvt_pk_bf16_f32 v79, v142, v143
    ds_read_b64_tr_b16 v[52:53], v4 offset:13312
    ds_read_b64_tr_b16 v[54:55], v4 offset:13824
    s_waitcnt lgkmcnt(4)
    v_mfma_f32_32x32x16_bf16 v[56:71], v[44:47], v[76:79], v[56:71]
    v_fma_f32 v144, v144, s36, v11
    v_fma_f32 v145, v145, s36, v11
    v_fma_f32 v146, v146, s36, v11
    v_fma_f32 v147, v147, s36, v11
    v_fma_f32 v148, v148, s36, v11
    v_fma_f32 v149, v149, s36, v11
    v_fma_f32 v150, v150, s36, v11
    v_fma_f32 v151, v151, s36, v11
    v_exp_f32 v144, v144
    v_exp_f32 v145, v145
    v_exp_f32 v146, v146
    v_exp_f32 v147, v147
    v_exp_f32 v148, v148
    v_exp_f32 v149, v149
    v_exp_f32 v150, v150
    v_exp_f32 v151, v151
    v_cvt_pk_bf16_f32 v80, v144, v145
    v_cvt_pk_bf16_f32 v81, v146, v147
    v_cvt_pk_bf16_f32 v82, v148, v149
    v_cvt_pk_bf16_f32 v83, v150, v151
    ds_read_b64_tr_b16 v[40:41], v4 offset:16384
    ds_read_b64_tr_b16 v[42:43], v4 offset:16896
    s_waitcnt lgkmcnt(4)
    v_mfma_f32_32x32x16_bf16 v[56:71], v[48:51], v[80:83], v[56:71]
    v_fma_f32 v152, v152, s36, v11
    v_fma_f32 v153, v153, s36, v11
    v_fma_f32 v154, v154, s36, v11
    v_fma_f32 v155, v155, s36, v11
    v_fma_f32 v156, v156, s36, v11
    v_fma_f32 v157, v157, s36, v11
    v_fma_f32 v158, v158, s36, v11
    v_fma_f32 v159, v159, s36, v11
    v_exp_f32 v152, v152
    v_exp_f32 v153, v153
    v_exp_f32 v154, v154
    v_exp_f32 v155, v155
    v_exp_f32 v156, v156
    v_exp_f32 v157, v157
    v_exp_f32 v158, v158
    v_exp_f32 v159, v159
    v_cvt_pk_bf16_f32 v84, v152, v153
    v_cvt_pk_bf16_f32 v85, v154, v155
    v_cvt_pk_bf16_f32 v86, v156, v157
    v_cvt_pk_bf16_f32 v87, v158, v159
    ds_read_b64_tr_b16 v[44:45], v4 offset:17408
    ds_read_b64_tr_b16 v[46:47], v4 offset:17920
    s_waitcnt lgkmcnt(4)
    v_mfma_f32_32x32x16_bf16 v[56:71], v[52:55], v[84:87], v[56:71]
    v_fma_f32 v160, v160, s36, v11
    v_fma_f32 v161, v161, s36, v11
    v_fma_f32 v162, v162, s36, v11
    v_fma_f32 v163, v163, s36, v11
    v_fma_f32 v164, v164, s36, v11
    v_fma_f32 v165, v165, s36, v11
    v_fma_f32 v166, v166, s36, v11
    v_fma_f32 v167, v167, s36, v11
    v_exp_f32 v160, v160
    v_exp_f32 v161, v161
    v_exp_f32 v162, v162
    v_exp_f32 v163, v163
    v_exp_f32 v164, v164
    v_exp_f32 v165, v165
    v_exp_f32 v166, v166
    v_exp_f32 v167, v167
    v_cvt_pk_bf16_f32 v72, v160, v161
    v_cvt_pk_bf16_f32 v73, v162, v163
    v_cvt_pk_bf16_f32 v74, v164, v165
    v_cvt_pk_bf16_f32 v75, v166, v167
    ds_read_b64_tr_b16 v[48:49], v4 offset:20480
    ds_read_b64_tr_b16 v[50:51], v4 offset:20992
    s_waitcnt lgkmcnt(4)
    v_mfma_f32_32x32x16_bf16 v[56:71], v[40:43], v[72:75], v[56:71]
    v_fma_f32 v168, v168, s36, v11
    v_fma_f32 v169, v169, s36, v11
    v_fma_f32 v170, v170, s36, v11
    v_fma_f32 v171, v171, s36, v11
    v_fma_f32 v172, v172, s36, v11
    v_fma_f32 v173, v173, s36, v11
    v_fma_f32 v174, v174, s36, v11
    v_fma_f32 v175, v175, s36, v11
    v_exp_f32 v168, v168
    v_exp_f32 v169, v169
    v_exp_f32 v170, v170
    v_exp_f32 v171, v171
    v_exp_f32 v172, v172
    v_exp_f32 v173, v173
    v_exp_f32 v174, v174
    v_exp_f32 v175, v175
    v_cvt_pk_bf16_f32 v76, v168, v169
    v_cvt_pk_bf16_f32 v77, v170, v171
    v_cvt_pk_bf16_f32 v78, v172, v173
    v_cvt_pk_bf16_f32 v79, v174, v175
    ds_read_b64_tr_b16 v[52:53], v4 offset:21504
    ds_read_b64_tr_b16 v[54:55], v4 offset:22016
    s_waitcnt lgkmcnt(4)
    v_mfma_f32_32x32x16_bf16 v[56:71], v[44:47], v[76:79], v[56:71]
    v_fma_f32 v176, v176, s36, v11
    v_fma_f32 v177, v177, s36, v11
    v_fma_f32 v178, v178, s36, v11
    v_fma_f32 v179, v179, s36, v11
    v_fma_f32 v180, v180, s36, v11
    v_fma_f32 v181, v181, s36, v11
    v_fma_f32 v182, v182, s36, v11
    v_fma_f32 v183, v183, s36, v11
    v_exp_f32 v176, v176
    v_exp_f32 v177, v177
    v_exp_f32 v178, v178
    v_exp_f32 v179, v179
    v_exp_f32 v180, v180
    v_exp_f32 v181, v181
    v_exp_f32 v182, v182
    v_exp_f32 v183, v183
    v_cvt_pk_bf16_f32 v80, v176, v177
    v_cvt_pk_bf16_f32 v81, v178, v179
    v_cvt_pk_bf16_f32 v82, v180, v181
    v_cvt_pk_bf16_f32 v83, v182, v183
    ds_read_b64_tr_b16 v[40:41], v4 offset:24576
    ds_read_b64_tr_b16 v[42:43], v4 offset:25088
    s_waitcnt lgkmcnt(4)
    v_mfma_f32_32x32x16_bf16 v[56:71], v[48:51], v[80:83], v[56:71]
    v_fma_f32 v184, v184, s36, v11
    v_fma_f32 v185, v185, s36, v11
    v_fma_f32 v186, v186, s36, v11
    v_fma_f32 v187, v187, s36, v11
    v_fma_f32 v188, v188, s36, v11
    v_fma_f32 v189, v189, s36, v11
    v_fma_f32 v190, v190, s36, v11
    v_fma_f32 v191, v191, s36, v11
    v_exp_f32 v184, v184
    v_exp_f32 v185, v185
    v_exp_f32 v186, v186
    v_exp_f32 v187, v187
    v_exp_f32 v188, v188
    v_exp_f32 v189, v189
    v_exp_f32 v190, v190
    v_exp_f32 v191, v191
    v_cvt_pk_bf16_f32 v84, v184, v185
    v_cvt_pk_bf16_f32 v85, v186, v187
    v_cvt_pk_bf16_f32 v86, v188, v189
    v_cvt_pk_bf16_f32 v87, v190, v191
    ds_read_b64_tr_b16 v[44:45], v4 offset:25600
    ds_read_b64_tr_b16 v[46:47], v4 offset:26112
    s_waitcnt lgkmcnt(4)
    v_mfma_f32_32x32x16_bf16 v[56:71], v[52:55], v[84:87], v[56:71]
    v_fma_f32 v192, v192, s36, v11
    v_fma_f32 v193, v193, s36, v11
    v_fma_f32 v194, v194, s36, v11
    v_fma_f32 v195, v195, s36, v11
    v_fma_f32 v196, v196, s36, v11
    v_fma_f32 v197, v197, s36, v11
    v_fma_f32 v198, v198, s36, v11
    v_fma_f32 v199, v199, s36, v11
    v_exp_f32 v192, v192
    v_exp_f32 v193, v193
    v_exp_f32 v194, v194
    v_exp_f32 v195, v195
    v_exp_f32 v196, v196
    v_exp_f32 v197, v197
    v_exp_f32 v198, v198
    v_exp_f32 v199, v199
    v_cvt_pk_bf16_f32 v72, v192, v193
    v_cvt_pk_bf16_f32 v73, v194, v195
    v_cvt_pk_bf16_f32 v74, v196, v197
    v_cvt_pk_bf16_f32 v75, v198, v199
    ds_read_b64_tr_b16 v[48:49], v4 offset:28672
    ds_read_b64_tr_b16 v[50:51], v4 offset:29184
    s_waitcnt lgkmcnt(4)
    v_mfma_f32_32x32x16_bf16 v[56:71], v[40:43], v[72:75], v[56:71]
    v_fma_f32 v200, v200, s36, v11
    v_fma_f32 v201, v201, s36, v11
    v_fma_f32 v202, v202, s36, v11
    v_fma_f32 v203, v203, s36, v11
    v_fma_f32 v204, v204, s36, v11
    v_fma_f32 v205, v205, s36, v11
    v_fma_f32 v206, v206, s36, v11
    v_fma_f32 v207, v207, s36, v11
    v_exp_f32 v200, v200
    v_exp_f32 v201, v201
    v_exp_f32 v202, v202
    v_exp_f32 v203, v203
    v_exp_f32 v204, v204
    v_exp_f32 v205, v205
    v_exp_f32 v206, v206
    v_exp_f32 v207, v207
    v_cvt_pk_bf16_f32 v76, v200, v201
    v_cvt_pk_bf16_f32 v77, v202, v203
    v_cvt_pk_bf16_f32 v78, v204, v205
    v_cvt_pk_bf16_f32 v79, v206, v207
    ds_read_b64_tr_b16 v[52:53], v4 offset:29696
    ds_read_b64_tr_b16 v[54:55], v4 offset:30208
    s_waitcnt lgkmcnt(4)
    v_mfma_f32_32x32x16_bf16 v[56:71], v[44:47], v[76:79], v[56:71]
    v_fma_f32 v208, v208, s36, v11
    v_fma_f32 v209, v209, s36, v11
    v_fma_f32 v210, v210, s36, v11
    v_fma_f32 v211, v211, s36, v11
    v_fma_f32 v212, v212, s36, v11
    v_fma_f32 v213, v213, s36, v11
    v_fma_f32 v214, v214, s36, v11
    v_fma_f32 v215, v215, s36, v11
    v_exp_f32 v208, v208
    v_exp_f32 v209, v209
    v_exp_f32 v210, v210
    v_exp_f32 v211, v211
    v_exp_f32 v212, v212
    v_exp_f32 v213, v213
    v_exp_f32 v214, v214
    v_exp_f32 v215, v215
    v_cvt_pk_bf16_f32 v80, v208, v209
    v_cvt_pk_bf16_f32 v81, v210, v211
    v_cvt_pk_bf16_f32 v82, v212, v213
    v_cvt_pk_bf16_f32 v83, v214, v215
    ds_read_b64_tr_b16 v[40:41], v4 offset:32768
    ds_read_b64_tr_b16 v[42:43], v4 offset:33280
    s_waitcnt lgkmcnt(4)
    v_mfma_f32_32x32x16_bf16 v[56:71], v[48:51], v[80:83], v[56:71]
    v_fma_f32 v216, v216, s36, v11
    v_fma_f32 v217, v217, s36, v11
    v_fma_f32 v218, v218, s36, v11
    v_fma_f32 v219, v219, s36, v11
    v_fma_f32 v220, v220, s36, v11
    v_fma_f32 v221, v221, s36, v11
    v_fma_f32 v222, v222, s36, v11
    v_fma_f32 v223, v223, s36, v11
    v_exp_f32 v216, v216
    v_exp_f32 v217, v217
    v_exp_f32 v218, v218
    v_exp_f32 v219, v219
    v_exp_f32 v220, v220
    v_exp_f32 v221, v221
    v_exp_f32 v222, v222
    v_exp_f32 v223, v223
    v_cvt_pk_bf16_f32 v84, v216, v217
    v_cvt_pk_bf16_f32 v85, v218, v219
    v_cvt_pk_bf16_f32 v86, v220, v221
    v_cvt_pk_bf16_f32 v87, v222, v223
    ds_read_b64_tr_b16 v[44:45], v4 offset:33792
    ds_read_b64_tr_b16 v[46:47], v4 offset:34304
    s_waitcnt lgkmcnt(4)
    v_mfma_f32_32x32x16_bf16 v[56:71], v[52:55], v[84:87], v[56:71]
    v_fma_f32 v224, v224, s36, v11
    v_fma_f32 v225, v225, s36, v11
    v_fma_f32 v226, v226, s36, v11
    v_fma_f32 v227, v227, s36, v11
    v_fma_f32 v228, v228, s36, v11
    v_fma_f32 v229, v229, s36, v11
    v_fma_f32 v230, v230, s36, v11
    v_fma_f32 v231, v231, s36, v11
    v_exp_f32 v224, v224
    v_exp_f32 v225, v225
    v_exp_f32 v226, v226
    v_exp_f32 v227, v227
    v_exp_f32 v228, v228
    v_exp_f32 v229, v229
    v_exp_f32 v230, v230
    v_exp_f32 v231, v231
    v_cvt_pk_bf16_f32 v72, v224, v225
    v_cvt_pk_bf16_f32 v73, v226, v227
    v_cvt_pk_bf16_f32 v74, v228, v229
    v_cvt_pk_bf16_f32 v75, v230, v231
    s_waitcnt lgkmcnt(2)
    s_nop 0
    v_mfma_f32_32x32x16_bf16 v[56:71], v[40:43], v[72:75], v[56:71]
    v_fma_f32 v232, v232, s36, v11
    v_fma_f32 v233, v233, s36, v11
    v_fma_f32 v234, v234, s36, v11
    v_fma_f32 v235, v235, s36, v11
    v_fma_f32 v236, v236, s36, v11
    v_fma_f32 v237, v237, s36, v11
    v_fma_f32 v238, v238, s36, v11
    v_fma_f32 v239, v239, s36, v11
    v_exp_f32 v232, v232
    v_exp_f32 v233, v233
    v_exp_f32 v234, v234
    v_exp_f32 v235, v235
    v_exp_f32 v236, v236
    v_exp_f32 v237, v237
    v_exp_f32 v238, v238
    v_exp_f32 v239, v239
    v_cvt_pk_bf16_f32 v76, v232, v233
    v_cvt_pk_bf16_f32 v77, v234, v235
    v_cvt_pk_bf16_f32 v78, v236, v237
    v_cvt_pk_bf16_f32 v79, v238, v239
    s_waitcnt lgkmcnt(0)
    s_nop 0
    v_mfma_f32_32x32x16_bf16 v[56:71], v[44:47], v[76:79], v[56:71]
    s_nop 7
    s_nop 3
    v_mov_b32 v6, v68
    v_mov_b32 v7, v68
    s_nop 1
    v_permlane32_swap_b32 v6, v7
    v_rcp_f32 v8, v7
    s_nop 0
    v_cndmask_b32 v9, v8, 0, s[40:41]
    v_mul_f32 v56, v56, v8
    v_mul_f32 v57, v57, v8
    v_mul_f32 v58, v58, v8
    v_mul_f32 v59, v59, v8
    v_mul_f32 v60, v60, v8
    v_mul_f32 v61, v61, v8
    v_mul_f32 v62, v62, v8
    v_mul_f32 v63, v63, v8
    v_mul_f32 v64, v64, v8
    v_mul_f32 v65, v65, v8
    v_mul_f32 v66, v66, v8
    v_mul_f32 v67, v67, v8
    v_mul_f32 v68, v68, v9
    v_mul_f32 v69, v69, v9
    v_mul_f32 v70, v70, v9
    v_mul_f32 v71, v71, v9
    v_cvt_pk_bf16_f32 v72, v56, v57
    v_cvt_pk_bf16_f32 v73, v58, v59
    v_cvt_pk_bf16_f32 v74, v60, v61
    v_cvt_pk_bf16_f32 v75, v62, v63
    v_cvt_pk_bf16_f32 v76, v64, v65
    v_cvt_pk_bf16_f32 v77, v66, v67
    v_cvt_pk_bf16_f32 v78, v68, v69
    v_cvt_pk_bf16_f32 v79, v70, v71
    s_lshl_b32 s36, s35, 4
    s_add_u32 s36, s36, s33
    s_lshl_b32 s36, s36, 11
    s_add_u32 s36, s36, 13631488
    buffer_store_dwordx4 v[72:75], v2, s[4:7], s36 offen sc0 sc1
    buffer_store_dwordx4 v[76:79], v2, s[4:7], s36 offen offset:1024 sc0 sc1
    s_waitcnt vmcnt(0)
    v_mov_b32 v6, 131072
    v_mov_b32 v7, 1
    s_mov_b64 exec, 1
    ds_add_u32 v6, v7 offset:4
    s_mov_b64 exec, -1
K23_SPb:
    ds_read_b32 v7, v6 offset:4
    s_waitcnt lgkmcnt(0)
    v_readfirstlane_b32 s36, v7
    s_nop 0
    s_cmp_ge_u32 s36, 4
    s_cbranch_scc1 K23_SGb
    s_sleep 1
    s_branch K23_SPb
K23_SGb:
    s_cmp_lg_u32 s3, 0
    s_cbranch_scc1 K23_NOSIG
    s_lshr_b32 s36, s33, 2
    s_lshl_b32 s37, s34, 2
    s_add_u32 s36, s36, s37
    v_mov_b32 v6, 1
    v_mov_b32 v7, 0
    s_lshl_b32 s36, s36, 7
    s_add_u32 s36, s36, 15728640
    s_mov_b64 exec, 1
    buffer_atomic_add v6, v7, s[4:7], s36 offen sc1
    s_mov_b64 exec, -1
K23_NOSIG:
    s_cmp_ge_u32 s53, 7
    s_cbranch_scc1 K23_END0
    s_lshl_b32 s41, s3, 14
    s_add_u32 s41, s41, 0
    v_bfe_u32 v6, v1, 2, 2
    v_and_b32 v7, 3, v1
    v_bfe_u32 v8, v1, 4, 1
    v_lshrrev_b32 v9, 5, v1
    v_lshl_add_u32 v10, v8, 2, v7
    v_and_b32 v11, 1, v10
    v_lshlrev_b32 v11, 2, v11
    v_lshrrev_b32 v12, 1, v10
    v_or_b32 v11, v11, v12
    v_lshlrev_b32 v11, 3, v11
    v_bfe_u32 v13, v6, 1, 1
    v_lshlrev_b32 v13, 6, v13
    v_xor_b32 v11, v11, v13
    v_lshl_add_u32 v12, v9, 3, v6
    v_lshl_add_u32 v11, v12, 7, v11
    v_add_u32 v16, s41, v11
    v_add_u32 v17, 512, v16
    v_xor_b32 v18, 64, v16
    v_xor_b32 v19, 64, v17
    v_lshrrev_b32 v11, 3, v1
    v_and_b32 v12, 7, v1
    v_bfe_u32 v13, v1, 4, 1
    v_lshlrev_b32 v13, 2, v13
    v_xor_b32 v12, v12, v13
    v_lshlrev_b32 v12, 4, v12
    s_movk_i32 s36, 896
    v_mad_u32_u24 v20, v11, s36, v12
    s_mov_b32 s20, s16
    s_mov_b32 s21, s17
    s_mov_b32 s22, 401408
    s_mov_b32 s23, 0x00020000
    s_mul_i32 s42, s3, 100352
    s_lshl_b32 s36, s53, 7
    s_add_u32 s42, s42, s36
    s_add_u32 m0, s41, 0
    s_add_u32 s36, s42, 7168
    buffer_load_dwordx4 v20, s[20:23], s42 offen lds
    s_add_u32 m0, s41, 1024
    s_nop 0
    buffer_load_dwordx4 v20, s[20:23], s36 offen lds
    s_add_u32 s42, s42, 14336
    s_add_u32 m0, s41, 2048
    s_add_u32 s36, s42, 7168
    buffer_load_dwordx4 v20, s[20:23], s42 offen lds
    s_add_u32 m0, s41, 3072
    s_nop 0
    buffer_load_dwordx4 v20, s[20:23], s36 offen lds
    s_add_u32 s42, s42, 10752
    s_add_u32 m0, s41, 4096
    s_add_u32 s36, s42, 7168
    buffer_load_dwordx4 v20, s[20:23], s42 offen lds
    s_add_u32 m0, s41, 5120
    s_nop 0
    buffer_load_dwordx4 v20, s[20:23], s36 offen lds
    s_add_u32 s42, s42, 14336
    s_add_u32 m0, s41, 6144
    s_add_u32 s36, s42, 7168
    buffer_load_dwordx4 v20, s[20:23], s42 offen lds
    s_add_u32 m0, s41, 7168
    s_nop 0
    buffer_load_dwordx4 v20, s[20:23], s36 offen lds
    s_add_u32 s42, s42, 10752
    s_add_u32 m0, s41, 8192
    s_add_u32 s36, s42, 7168
    buffer_load_dwordx4 v20, s[20:23], s42 offen lds
    s_add_u32 m0, s41, 9216
    s_nop 0
    buffer_load_dwordx4 v20, s[20:23], s36 offen lds
    s_add_u32 s42, s42, 14336
    s_add_u32 m0, s41, 10240
    s_add_u32 s36, s42, 7168
    buffer_load_dwordx4 v20, s[20:23], s42 offen lds
    s_add_u32 m0, s41, 11264
    s_nop 0
    buffer_load_dwordx4 v20, s[20:23], s36 offen lds
    s_add_u32 s42, s42, 10752
    s_add_u32 m0, s41, 12288
    s_add_u32 s36, s42, 7168
    buffer_load_dwordx4 v20, s[20:23], s42 offen lds
    s_add_u32 m0, s41, 13312
    s_nop 0
    buffer_load_dwordx4 v20, s[20:23], s36 offen lds
    s_add_u32 s42, s42, 14336
    s_add_u32 m0, s41, 14336
    s_add_u32 s36, s42, 7168
    buffer_load_dwordx4 v20, s[20:23], s42 offen lds
    s_add_u32 m0, s41, 15360
    s_nop 0
    buffer_load_dwordx4 v20, s[20:23], s36 offen lds
    s_add_u32 s42, s42, 10752
    s_lshr_b32 s36, s52, 1
    s_lshl_b32 s36, s36, 2
    s_add_u32 s36, s36, s3
    s_lshl_b32 s36, s36, 7
    s_add_u32 s36, s36, 15728640
    v_mov_b32 v7, 0
K23_POLL:
    buffer_load_dword v6, v7, s[4:7], s36 offen sc0 sc1
    s_waitcnt vmcnt(0)
    v_readfirstlane_b32 s37, v6
    s_nop 0
    s_cmp_ge_u32 s37, 4
    s_cbranch_scc1 K23_READY
    s_sleep 8
    s_branch K23_POLL
K23_READY:
    s_lshl_b32 s43, s52, 16
    s_lshl_b32 s36, s3, 13
    s_add_u32 s43, s43, s36
    s_add_u32 s43, s43, 13631488
    buffer_load_dwordx4 v[160:163], v2, s[4:7], s43 offen sc0 sc1
    s_add_u32 s36, s43, 32768
    buffer_load_dwordx4 v[164:167], v2, s[4:7], s36 offen sc0 sc1
    s_add_u32 s43, s43, 1024
    buffer_load_dwordx4 v[168:171], v2, s[4:7], s43 offen sc0 sc1
    s_add_u32 s36, s43, 32768
    buffer_load_dwordx4 v[172:175], v2, s[4:7], s36 offen sc0 sc1
    s_add_u32 s43, s43, 1024
    buffer_load_dwordx4 v[176:179], v2, s[4:7], s43 offen sc0 sc1
    s_add_u32 s36, s43, 32768
    buffer_load_dwordx4 v[180:183], v2, s[4:7], s36 offen sc0 sc1
    s_add_u32 s43, s43, 1024
    buffer_load_dwordx4 v[184:187], v2, s[4:7], s43 offen sc0 sc1
    s_add_u32 s36, s43, 32768
    buffer_load_dwordx4 v[188:191], v2, s[4:7], s36 offen sc0 sc1
    s_add_u32 s43, s43, 1024
    buffer_load_dwordx4 v[192:195], v2, s[4:7], s43 offen sc0 sc1
    s_add_u32 s36, s43, 32768
    buffer_load_dwordx4 v[196:199], v2, s[4:7], s36 offen sc0 sc1
    s_add_u32 s43, s43, 1024
    buffer_load_dwordx4 v[200:203], v2, s[4:7], s43 offen sc0 sc1
    s_add_u32 s36, s43, 32768
    buffer_load_dwordx4 v[204:207], v2, s[4:7], s36 offen sc0 sc1
    s_add_u32 s43, s43, 1024
    buffer_load_dwordx4 v[208:211], v2, s[4:7], s43 offen sc0 sc1
    s_add_u32 s36, s43, 32768
    buffer_load_dwordx4 v[212:215], v2, s[4:7], s36 offen sc0 sc1
    s_add_u32 s43, s43, 1024
    buffer_load_dwordx4 v[216:219], v2, s[4:7], s43 offen sc0 sc1
    s_add_u32 s36, s43, 32768
    buffer_load_dwordx4 v[220:223], v2, s[4:7], s36 offen sc0 sc1
    s_add_u32 s43, s43, 1024
    ds_read_b64_tr_b16 v[24:25], v16 offset:0
    ds_read_b64_tr_b16 v[26:27], v17 offset:0
    ds_read_b64_tr_b16 v[28:29], v18 offset:0
    ds_read_b64_tr_b16 v[30:31], v19 offset:0
    ds_read_b64_tr_b16 v[32:33], v16 offset:2048
    ds_read_b64_tr_b16 v[34:35], v17 offset:2048
    ds_read_b64_tr_b16 v[36:37], v18 offset:2048
    ds_read_b64_tr_b16 v[38:39], v19 offset:2048
    s_waitcnt lgkmcnt(4)
    s_waitcnt vmcnt(14)
    v_mfma_f32_32x32x16_bf16 v[96:111], v[24:27], v[160:163], 0
    v_mfma_f32_32x32x16_bf16 v[112:127], v[28:31], v[160:163], 0
    v_mfma_f32_32x32x16_bf16 v[128:143], v[24:27], v[164:167], 0
    v_mfma_f32_32x32x16_bf16 v[144:159], v[28:31], v[164:167], 0
    ds_read_b64_tr_b16 v[24:25], v16 offset:4096
    ds_read_b64_tr_b16 v[26:27], v17 offset:4096
    ds_read_b64_tr_b16 v[28:29], v18 offset:4096
    ds_read_b64_tr_b16 v[30:31], v19 offset:4096
    s_waitcnt lgkmcnt(4)
    s_waitcnt vmcnt(12)
    v_mfma_f32_32x32x16_bf16 v[96:111], v[32:35], v[168:171], v[96:111]
    v_mfma_f32_32x32x16_bf16 v[112:127], v[36:39], v[168:171], v[112:127]
    v_mfma_f32_32x32x16_bf16 v[128:143], v[32:35], v[172:175], v[128:143]
    v_mfma_f32_32x32x16_bf16 v[144:159], v[36:39], v[172:175], v[144:159]
    ds_read_b64_tr_b16 v[32:33], v16 offset:6144
    ds_read_b64_tr_b16 v[34:35], v17 offset:6144
    ds_read_b64_tr_b16 v[36:37], v18 offset:6144
    ds_read_b64_tr_b16 v[38:39], v19 offset:6144
    s_waitcnt lgkmcnt(4)
    s_waitcnt vmcnt(10)
    v_mfma_f32_32x32x16_bf16 v[96:111], v[24:27], v[176:179], v[96:111]
    v_mfma_f32_32x32x16_bf16 v[112:127], v[28:31], v[176:179], v[112:127]
    v_mfma_f32_32x32x16_bf16 v[128:143], v[24:27], v[180:183], v[128:143]
    v_mfma_f32_32x32x16_bf16 v[144:159], v[28:31], v[180:183], v[144:159]
    ds_read_b64_tr_b16 v[24:25], v16 offset:8192
    ds_read_b64_tr_b16 v[26:27], v17 offset:8192
    ds_read_b64_tr_b16 v[28:29], v18 offset:8192
    ds_read_b64_tr_b16 v[30:31], v19 offset:8192
    s_waitcnt lgkmcnt(4)
    s_waitcnt vmcnt(8)
    v_mfma_f32_32x32x16_bf16 v[96:111], v[32:35], v[184:187], v[96:111]
    v_mfma_f32_32x32x16_bf16 v[112:127], v[36:39], v[184:187], v[112:127]
    v_mfma_f32_32x32x16_bf16 v[128:143], v[32:35], v[188:191], v[128:143]
    v_mfma_f32_32x32x16_bf16 v[144:159], v[36:39], v[188:191], v[144:159]
    ds_read_b64_tr_b16 v[32:33], v16 offset:10240
    ds_read_b64_tr_b16 v[34:35], v17 offset:10240
    ds_read_b64_tr_b16 v[36:37], v18 offset:10240
    ds_read_b64_tr_b16 v[38:39], v19 offset:10240
    s_waitcnt lgkmcnt(4)
    s_waitcnt vmcnt(6)
    v_mfma_f32_32x32x16_bf16 v[96:111], v[24:27], v[192:195], v[96:111]
    v_mfma_f32_32x32x16_bf16 v[112:127], v[28:31], v[192:195], v[112:127]
    v_mfma_f32_32x32x16_bf16 v[128:143], v[24:27], v[196:199], v[128:143]
    v_mfma_f32_32x32x16_bf16 v[144:159], v[28:31], v[196:199], v[144:159]
    ds_read_b64_tr_b16 v[24:25], v16 offset:12288
    ds_read_b64_tr_b16 v[26:27], v17 offset:12288
    ds_read_b64_tr_b16 v[28:29], v18 offset:12288
    ds_read_b64_tr_b16 v[30:31], v19 offset:12288
    s_waitcnt lgkmcnt(4)
    s_waitcnt vmcnt(4)
    v_mfma_f32_32x32x16_bf16 v[96:111], v[32:35], v[200:203], v[96:111]
    v_mfma_f32_32x32x16_bf16 v[112:127], v[36:39], v[200:203], v[112:127]
    v_mfma_f32_32x32x16_bf16 v[128:143], v[32:35], v[204:207], v[128:143]
    v_mfma_f32_32x32x16_bf16 v[144:159], v[36:39], v[204:207], v[144:159]
    ds_read_b64_tr_b16 v[32:33], v16 offset:14336
    ds_read_b64_tr_b16 v[34:35], v17 offset:14336
    ds_read_b64_tr_b16 v[36:37], v18 offset:14336
    ds_read_b64_tr_b16 v[38:39], v19 offset:14336
    s_waitcnt lgkmcnt(4)
    s_waitcnt vmcnt(2)
    v_mfma_f32_32x32x16_bf16 v[96:111], v[24:27], v[208:211], v[96:111]
    v_mfma_f32_32x32x16_bf16 v[112:127], v[28:31], v[208:211], v[112:127]
    v_mfma_f32_32x32x16_bf16 v[128:143], v[24:27], v[212:215], v[128:143]
    v_mfma_f32_32x32x16_bf16 v[144:159], v[28:31], v[212:215], v[144:159]
    s_waitcnt lgkmcnt(0)
    s_waitcnt vmcnt(0)
    v_mfma_f32_32x32x16_bf16 v[96:111], v[32:35], v[216:219], v[96:111]
    v_mfma_f32_32x32x16_bf16 v[112:127], v[36:39], v[216:219], v[112:127]
    v_mfma_f32_32x32x16_bf16 v[128:143], v[32:35], v[220:223], v[128:143]
    v_mfma_f32_32x32x16_bf16 v[144:159], v[36:39], v[220:223], v[144:159]
    v_add_u32 v6, s41, v2
    s_nop 7
    ds_write_b128 v6, v[96:99] offset:0
    ds_write_b128 v6, v[100:103] offset:1024
    ds_write_b128 v6, v[104:107] offset:2048
    ds_write_b128 v6, v[108:111] offset:3072
    ds_write_b128 v6, v[112:115] offset:4096
    ds_write_b128 v6, v[116:119] offset:5120
    ds_write_b128 v6, v[120:123] offset:6144
    ds_write_b128 v6, v[124:127] offset:7168
    ds_write_b128 v6, v[128:131] offset:8192
    ds_write_b128 v6, v[132:135] offset:9216
    ds_write_b128 v6, v[136:139] offset:10240
    ds_write_b128 v6, v[140:143] offset:11264
    ds_write_b128 v6, v[144:147] offset:12288
    ds_write_b128 v6, v[148:151] offset:13312
    ds_write_b128 v6, v[152:155] offset:14336
    ds_write_b128 v6, v[156:159] offset:15360
K23_FIN:
    s_mov_b32 s24, s18
    s_mov_b32 s25, s19
    s_mov_b32 s26, 1835008
    s_mov_b32 s27, 0x00020000
    s_mov_b32 s28, s56
    s_mov_b32 s29, s57
    s_mov_b32 s30, 1835008
    s_mov_b32 s31, 0x00020000
    s_and_b32 s36, s97, 3
    s_lshr_b32 s37, s36, 1
    s_lshl_b32 s38, s52, 1
    s_add_u32 s38, s38, s37
    s_mul_i32 s38, s38, 28672
    s_lshl_b32 s39, s53, 7
    s_add_u32 s38, s38, s39
    s_and_b32 s37, s97, 1
    s_lshl_b32 s37, s37, 6
    s_add_u32 s38, s38, s37
    s_lshr_b32 s37, s97, 2
    s_lshl_b32 s39, s37, 4
    s_add_u32 s38, s38, s39
    v_and_b32 v8, 31, v1
    s_movk_i32 s39, 896
    v_mul_u32_u24 v8, s39, v8
    v_lshrrev_b32 v9, 5, v1
    v_lshl_add_u32 v16, v9, 5, v8
    buffer_load_dwordx4 v[120:123], v16, s[24:27], s38 offen
    s_lshl_b32 s36, s36, 12
    s_lshl_b32 s37, s37, 11
    s_add_u32 s36, s36, s37
    v_add_u32 v8, s36, v2
    s_waitcnt lgkmcnt(0)
    s_barrier
    ds_read_b128 v[48:51], v8 offset:0
    ds_read_b128 v[52:55], v8 offset:1024
    ds_read_b128 v[64:67], v8 offset:16384
    ds_read_b128 v[68:71], v8 offset:17408
    ds_read_b128 v[80:83], v8 offset:32768
    ds_read_b128 v[84:87], v8 offset:33792
    ds_read_b128 v[96:99], v8 offset:49152
    ds_read_b128 v[100:103], v8 offset:50176
    v_add_u32 v8, 65536, v8
    ds_read_b128 v[56:59], v8 offset:0
    ds_read_b128 v[60:63], v8 offset:1024
    ds_read_b128 v[72:75], v8 offset:16384
    ds_read_b128 v[76:79], v8 offset:17408
    ds_read_b128 v[88:91], v8 offset:32768
    ds_read_b128 v[92:95], v8 offset:33792
    ds_read_b128 v[104:107], v8 offset:49152
    ds_read_b128 v[108:111], v8 offset:50176
    s_waitcnt lgkmcnt(0)
    v_add_f32 v48, v48, v64
    v_add_f32 v80, v80, v96
    v_add_f32 v49, v49, v65
    v_add_f32 v81, v81, v97
    v_add_f32 v50, v50, v66
    v_add_f32 v82, v82, v98
    v_add_f32 v51, v51, v67
    v_add_f32 v83, v83, v99
    v_add_f32 v52, v52, v68
    v_add_f32 v84, v84, v100
    v_add_f32 v53, v53, v69
    v_add_f32 v85, v85, v101
    v_add_f32 v54, v54, v70
    v_add_f32 v86, v86, v102
    v_add_f32 v55, v55, v71
    v_add_f32 v87, v87, v103
    v_add_f32 v56, v56, v72
    v_add_f32 v88, v88, v104
    v_add_f32 v57, v57, v73
    v_add_f32 v89, v89, v105
    v_add_f32 v58, v58, v74
    v_add_f32 v90, v90, v106
    v_add_f32 v59, v59, v75
    v_add_f32 v91, v91, v107
    v_add_f32 v60, v60, v76
    v_add_f32 v92, v92, v108
    v_add_f32 v61, v61, v77
    v_add_f32 v93, v93, v109
    v_add_f32 v62, v62, v78
    v_add_f32 v94, v94, v110
    v_add_f32 v63, v63, v79
    v_add_f32 v95, v95, v111
    v_add_f32 v48, v48, v80
    v_add_f32 v49, v49, v81
    v_add_f32 v50, v50, v82
    v_add_f32 v51, v51, v83
    v_add_f32 v52, v52, v84
    v_add_f32 v53, v53, v85
    v_add_f32 v54, v54, v86
    v_add_f32 v55, v55, v87
    v_add_f32 v56, v56, v88
    v_add_f32 v57, v57, v89
    v_add_f32 v58, v58, v90
    v_add_f32 v59, v59, v91
    v_add_f32 v60, v60, v92
    v_add_f32 v61, v61, v93
    v_add_f32 v62, v62, v94
    v_add_f32 v63, v63, v95
    v_mul_f32 v128, 0xbfb8aa3b, v56
    v_mul_f32 v129, 0xbfb8aa3b, v57
    v_mul_f32 v130, 0xbfb8aa3b, v58
    v_mul_f32 v131, 0xbfb8aa3b, v59
    v_mul_f32 v132, 0xbfb8aa3b, v60
    v_mul_f32 v133, 0xbfb8aa3b, v61
    v_mul_f32 v134, 0xbfb8aa3b, v62
    v_mul_f32 v135, 0xbfb8aa3b, v63
    v_exp_f32 v128, v128
    v_exp_f32 v129, v129
    v_exp_f32 v130, v130
    v_exp_f32 v131, v131
    v_exp_f32 v132, v132
    v_exp_f32 v133, v133
    v_exp_f32 v134, v134
    v_exp_f32 v135, v135
    v_add_f32 v128, 1.0, v128
    v_add_f32 v129, 1.0, v129
    v_add_f32 v130, 1.0, v130
    v_add_f32 v131, 1.0, v131
    v_add_f32 v132, 1.0, v132
    v_add_f32 v133, 1.0, v133
    v_add_f32 v134, 1.0, v134
    v_add_f32 v135, 1.0, v135
    v_rcp_f32 v128, v128
    v_rcp_f32 v129, v129
    v_rcp_f32 v130, v130
    v_rcp_f32 v131, v131
    v_rcp_f32 v132, v132
    v_rcp_f32 v133, v133
    v_rcp_f32 v134, v134
    v_rcp_f32 v135, v135
    v_mul_f32 v56, v56, v128
    v_mul_f32 v57, v57, v129
    v_mul_f32 v58, v58, v130
    v_mul_f32 v59, v59, v131
    v_mul_f32 v60, v60, v132
    v_mul_f32 v61, v61, v133
    v_mul_f32 v62, v62, v134
    v_mul_f32 v63, v63, v135
    s_waitcnt vmcnt(0)
    v_lshlrev_b32 v128, 16, v120
    v_and_b32 v129, 0xffff0000, v120
    v_lshlrev_b32 v130, 16, v121
    v_and_b32 v131, 0xffff0000, v121
    v_lshlrev_b32 v132, 16, v122
    v_and_b32 v133, 0xffff0000, v122
    v_lshlrev_b32 v134, 16, v123
    v_and_b32 v135, 0xffff0000, v123
    v_fma_f32 v128, v48, v56, v128
    v_fma_f32 v129, v49, v57, v129
    v_fma_f32 v130, v50, v58, v130
    v_fma_f32 v131, v51, v59, v131
    v_fma_f32 v132, v52, v60, v132
    v_fma_f32 v133, v53, v61, v133
    v_fma_f32 v134, v54, v62, v134
    v_fma_f32 v135, v55, v63, v135
    v_cvt_pk_bf16_f32 v120, v128, v129
    v_cvt_pk_bf16_f32 v121, v130, v131
    v_cvt_pk_bf16_f32 v122, v132, v133
    v_cvt_pk_bf16_f32 v123, v134, v135
    buffer_store_dwordx4 v[120:123], v16, s[28:31], s38 offen
K23_END0:
K23_END:
K1_END:
    s_endpgm
.section .rodata,"a"
.p2align 6
.p2align 6
.amdhsa_kernel recurrent_scan__sliding_block__glu_gated_bilinear__prompt_kernel
  .amdhsa_next_free_vgpr 256
  .amdhsa_next_free_sgpr 102
  .amdhsa_accum_offset 256
  .amdhsa_group_segment_fixed_size 0
  .amdhsa_kernarg_size 80
  .amdhsa_user_sgpr_count 2
  .amdhsa_user_sgpr_kernarg_segment_ptr 1
  .amdhsa_system_sgpr_workgroup_id_x 1
.end_amdhsa_kernel
```
